```python
import torch

def _softmax(x, axis=-1):
    return torch.softmax(x, dim=axis)
def _gelu(x):
    return torch.nn.functional.gelu(x, approximate="tanh")
def _silu(x):
    return torch.nn.functional.silu(x)
def _sigmoid(x):
    return torch.sigmoid(x)
def _layernorm(x, axis=-1, eps=1e-5):
    m = x.mean(dim=axis, keepdim=True)
    v = x.var(dim=axis, keepdim=True, unbiased=False)
    return (x - m) / torch.sqrt(v + eps)
def _scatter_add(tgt, idx, src, axis=0):
    return tgt.clone().index_add_(axis, idx, src)
def _segment_sum(src, seg, n):
    out = torch.zeros((n,) + src.shape[1:], dtype=src.dtype)
    return out.index_add_(0, seg, src)
def _pad(x, pw):
    flat = tuple(v for pair in reversed(pw) for v in pair)
    return torch.nn.functional.pad(x, flat)

kernel_name = 'standalone__edge_featured_mpnn_gatedgcn__graph'

def setup_inputs():

    _w = (lambda a: (lambda t: t.to(torch.bfloat16) if t.is_floating_point() else t)(torch.as_tensor(a)))
    N, deg, D, De = 12500, 64, 64, max(4, 1)
    E = N * deg
    return {
        "x": _w((lambda *s: torch.randn(*s, dtype=torch.bfloat16) * 0.8)(N, D)),
        "e_attr": _w((lambda *s: torch.randn(*s, dtype=torch.bfloat16) * 0.8)(E, De)),
        "src": _w((lambda lo, hi, *s: torch.randint(lo, hi, s))(0, N, E).to(torch.int64)),
        "dst": _w((lambda lo, hi, *s: torch.randint(lo, hi, s))(0, N, E).to(torch.int64)),
        "w_a": _w((lambda *s: torch.randn(*s, dtype=torch.bfloat16) * 0.8)(D, D)),
        "w_b": _w((lambda *s: torch.randn(*s, dtype=torch.bfloat16) * 0.8)(D, D)),
        "w_c": _w((lambda *s: torch.randn(*s, dtype=torch.bfloat16) * 0.8)(De, D)),
        "w_u": _w((lambda *s: torch.randn(*s, dtype=torch.bfloat16) * 0.05)(D, D)),
        "w_v": _w((lambda *s: torch.randn(*s, dtype=torch.bfloat16) * 0.05)(D, D)),
    }

def reference(x, e_attr, src, dst, w_a, w_b, w_c, w_u, w_v):
    N, D = x.shape
    hv = x @ w_v
    g = x[dst] @ w_a + x[src] @ w_b + e_attr @ w_c
    eta = _sigmoid(g)
    denom = _segment_sum(eta, dst, N) + 1e-6
    eta_n = eta / denom[dst]
    agg = _segment_sum(eta_n * hv[src], dst, N)
    z = x @ w_u + agg
    relu_z = torch.where(z > 0, z, 0 * z)
    return x + relu_z
```

```asm
; @launch grid=(256,1,1) block=(512,1,1) lds=159104
.amdgcn_target "amdgcn-amd-amdhsa--gfx950"
.text
.globl standalone__edge_featured_mpnn_gatedgcn__graph_kernel
.p2align 8
.type standalone__edge_featured_mpnn_gatedgcn__graph_kernel,@function
standalone__edge_featured_mpnn_gatedgcn__graph_kernel:
    s_cmp_ge_u32 s2, 256
    s_cbranch_scc1 K_END
    s_load_dwordx16 s[64:79], s[0:1], 0
    s_load_dwordx8 s[80:87], s[0:1], 64
    s_getpc_b64 s[42:43]
K_PC0:
    v_and_b32 v6, 63, v0
    v_lshlrev_b32 v6, 7, v6
    v_add_u32 v7, 8192, v6
    v_cmp_le_u32 vcc, 448, v0
    s_mov_b64 exec, vcc
    s_cbranch_execz K_NOCPF
    global_load_dword v216, v6, s[42:43]
    v_cmp_gt_u32 vcc, K_LONG_ENTRY-K_PC0, v7
    s_mov_b64 exec, vcc
    global_load_dword v216, v7, s[42:43]
K_NOCPF:
    s_mov_b64 exec, -1
    s_mul_i32 s40, s2, 782
    v_add_u32 v4, s40, v0
    v_add_u32 v5, 391, v4
    v_cmp_gt_u32 vcc, 391, v0
    v_lshlrev_b32 v4, 4, v4
    v_mov_b32 v6, 0x40000000
    v_and_b32 v7, 255, v0
    v_cndmask_b32 v4, v6, v4, vcc
    v_lshlrev_b32 v7, 2, v7
    v_mov_b32 v217, 0
    ds_write_b32 v7, v217 offset:0
    s_mov_b32 s47, 0x20000
    s_mov_b32 s46, 3200000
    s_movk_i32 s58, 6256
    s_waitcnt lgkmcnt(0)
    s_mov_b32 s44, s70
    s_and_b32 s45, s71, 0xffff
    buffer_load_dwordx4 v[8:11], v4, s[44:47], 0 offen
    buffer_load_dwordx4 v[12:15], v4, s[44:47], s58 offen
    v_readfirstlane_b32 s3, v0
    s_mov_b32 s41, 200000
    v_cmp_gt_u32_e64 s[94:95], s41, v5
    s_mov_b64 s[92:93], vcc
    v_add_u32 v5, s58, v4
    s_and_b32 s13, s2, 7
    s_lshl_b32 s13, s13, 5
    s_lshr_b32 s40, s2, 3
    s_or_b32 s13, s13, s40
    s_and_b64 s[94:95], s[94:95], vcc
    s_lshr_b32 s3, s3, 6
    v_lshlrev_b32 v61, 4, v0
    v_and_b32 v96, 16, v0
    v_lshlrev_b32 v96, 1, v96
    v_and_b32 v97, 64, v0
    v_or_b32 v96, v96, v97
    v_xor_b32 v215, v96, v61
    global_load_dwordx4 v[40:43], v215, s[74:75]
    global_load_dwordx4 v[44:47], v215, s[80:81]
    v_lshrrev_b32 v62, 3, v0
    v_lshlrev_b32 v90, 8, v62
    v_add_u32 v90, s13, v90
    v_lshlrev_b32 v90, 7, v90
    v_and_b32 v63, 7, v0
    v_lshl_add_u32 v90, v63, 4, v90
    s_mov_b32 s20, s64
    s_and_b32 s21, s65, 0xffff
    s_mov_b32 s22, 1600000
    s_mov_b32 s23, 0x20000
    buffer_load_dwordx4 v[56:59], v90, s[20:23], 0 offen
    s_or_b32 s40, s2, s3
    s_cmp_lg_u32 s40, 0
    s_cbranch_scc1 K_NONONCE
    s_memrealtime s[40:41]
    s_waitcnt lgkmcnt(0)
    s_or_b32 s40, s40, 1
    v_mov_b32 v7, s40
    s_mov_b64 exec, 1
    global_store_dword v217, v7, s[84:85] sc1
    s_mov_b64 exec, -1
K_NONONCE:
    s_mov_b32 s48, s68
    s_and_b32 s49, s69, 0xffff
    s_mov_b32 s50, 3200000
    s_mov_b32 s51, 0x20000
    s_mov_b32 s52, s66
    s_and_b32 s53, s67, 0xffff
    s_mov_b32 s54, 6400000
    s_mov_b32 s55, 0x20000
    v_lshlrev_b32 v6, 1, v4
    v_lshlrev_b32 v7, 1, v5
    v_mov_b32 v74, v4
    v_mov_b32 v75, v5
    s_barrier
    buffer_load_dwordx4 v[24:27], v6, s[52:55], 0 offen
    buffer_load_dwordx4 v[28:31], v6, s[52:55], 0 offen offset:16
    s_cmp_lg_u32 s3, 7
    s_cbranch_scc1 K_NOTLB
    s_add_u32 s40, s2, 1
    v_and_b32 v76, 1, v0
    v_mul_u32_u24 v76, s40, v76
    s_mov_b32 s40, 37760
    v_mul_lo_u32 v76, v76, s40
    v_add_u32 v76, 3772288, v76
    s_mov_b64 exec, 3
    global_load_dword v216, v76, s[86:87]
    s_mov_b64 exec, 1
    global_load_dword v216, v217, s[82:83]
    global_load_dword v216, v217, s[84:85] offset:128
    s_mov_b64 exec, -1
K_NOTLB:
    v_mov_b32 v64, 0
    v_mov_b32 v65, 0
    v_mov_b32 v66, 0
    v_mov_b32 v67, 0
    v_mov_b32 v68, 12500
    v_mov_b32 v69, 12500
    v_mov_b32 v70, 12500
    v_mov_b32 v71, 12500
    v_lshlrev_b32 v72, 4, v0
    v_add_u32 v73, 53824, v72
    ds_write_b128 v72, v[64:67] offset:2048
    ds_write_b128 v72, v[64:67] offset:10240
    ds_write_b128 v72, v[64:67] offset:18432
    ds_write_b128 v72, v[64:67] offset:26624
    ds_write_b128 v72, v[64:67] offset:34816
    ds_write_b128 v72, v[64:67] offset:43008
    ds_write_b128 v73, v[68:71] offset:0
    ds_write_b128 v73, v[68:71] offset:8192
    ds_write_b128 v73, v[68:71] offset:16384
    v_cmp_gt_u32 vcc, 164, v0
    s_mov_b64 exec, vcc
    ds_write_b128 v72, v[64:67] offset:51200
    v_cmp_gt_u32 vcc, 82, v0
    s_mov_b64 exec, vcc
    ds_write_b128 v73, v[68:71] offset:24576
    s_mov_b64 exec, -1
    v_and_b32 v1, 63, v0
    v_and_b32 v2, 15, v0
    v_bfe_u32 v3, v0, 4, 2
    v_and_b32 v91, 127, v0
    v_lshlrev_b32 v91, 2, v91
    v_mul_u32_u24 v62, 144, v62
    v_lshl_add_u32 v62, v63, 4, v62
    v_add_u32 v62, 149376, v62
    v_add_u32 v63, 122720, v61
    s_mov_b64 s[16:17], s[86:87]
    s_lshr_b32 s18, s3, 1
    s_lshl_b32 s18, s18, 4
    s_and_b32 s19, s3, 1
    v_lshrrev_b32 v154, 2, v2
    v_lshl_add_u32 v150, v3, 3, v154
    v_lshlrev_b32 v150, 7, v150
    v_and_b32 v155, 3, v2
    v_lshl_add_u32 v150, v155, 3, v150
    s_lshl_b32 s40, s19, 6
    v_add_u32 v150, s40, v150
    v_and_b32 v4, 8, v2
    v_lshlrev_b32 v4, 2, v4
    v_and_b32 v5, 1, v3
    v_lshl_or_b32 v4, v5, 6, v4
    v_xor_b32 v150, v4, v150
    v_xor_b32 v214, 32, v150
    v_add_u32 v150, 122720, v150
    v_add_u32 v214, 122720, v214
    v_add_u32 v156, s18, v2
    v_mul_u32_u24 v151, 144, v156
    v_lshl_add_u32 v151, v3, 4, v151
    v_add_u32 v151, 149376, v151
    s_mov_b32 s28, s16
    s_and_b32 s29, s17, 0xffff
    s_mov_b32 s30, 3200256
    s_mov_b32 s31, 0x20000
    v_lshlrev_b32 v4, 8, v156
    v_add_u32 v4, s13, v4
    v_lshlrev_b32 v60, 8, v4
    v_lshl_add_u32 v60, v3, 4, v60
    s_lshl_b32 s40, s19, 7
    v_add_u32 v60, s40, v60
    v_cmp_eq_u32 vcc, 12500, v4
    v_mov_b32 v4, 0x7f000000
    v_mov_b32 v5, 0x7f007f00
    s_mov_b32 s56, 0x07060100
    s_mov_b32 s57, 0x07060302
    v_mov_b32 v76, 1
    s_waitcnt vmcnt(6)
    v_lshlrev_b32_sdwa v64, 2, v8 dst_sel:DWORD dst_unused:UNUSED_PAD src0_sel:DWORD src1_sel:BYTE_0
    v_lshlrev_b32_sdwa v65, 2, v9 dst_sel:DWORD dst_unused:UNUSED_PAD src0_sel:DWORD src1_sel:BYTE_0
    v_lshlrev_b32_sdwa v66, 2, v10 dst_sel:DWORD dst_unused:UNUSED_PAD src0_sel:DWORD src1_sel:BYTE_0
    v_lshlrev_b32_sdwa v67, 2, v11 dst_sel:DWORD dst_unused:UNUSED_PAD src0_sel:DWORD src1_sel:BYTE_0
    s_mov_b64 exec, s[92:93]
    ds_add_rtn_u32 v80, v64, v76 offset:0
    ds_add_rtn_u32 v81, v65, v76 offset:0
    ds_add_rtn_u32 v82, v66, v76 offset:0
    ds_add_rtn_u32 v83, v67, v76 offset:0
    s_mov_b64 exec, -1
    s_waitcnt vmcnt(5)
    v_lshlrev_b32_sdwa v68, 2, v12 dst_sel:DWORD dst_unused:UNUSED_PAD src0_sel:DWORD src1_sel:BYTE_0
    v_lshlrev_b32_sdwa v69, 2, v13 dst_sel:DWORD dst_unused:UNUSED_PAD src0_sel:DWORD src1_sel:BYTE_0
    v_lshlrev_b32_sdwa v70, 2, v14 dst_sel:DWORD dst_unused:UNUSED_PAD src0_sel:DWORD src1_sel:BYTE_0
    v_lshlrev_b32_sdwa v71, 2, v15 dst_sel:DWORD dst_unused:UNUSED_PAD src0_sel:DWORD src1_sel:BYTE_0
    s_mov_b64 exec, s[94:95]
    ds_add_rtn_u32 v84, v68, v76 offset:0
    ds_add_rtn_u32 v85, v69, v76 offset:0
    ds_add_rtn_u32 v86, v70, v76 offset:0
    ds_add_rtn_u32 v87, v71, v76 offset:0
    s_mov_b64 exec, -1
    s_cmp_eq_u32 s3, 7
    s_waitcnt vmcnt(5)
    s_cbranch_scc1 K_WOK
    s_waitcnt vmcnt(2)
K_WOK:
    ds_write_b128 v63, v[40:43]
    ds_write_b128 v63, v[44:47] offset:8192
    ds_write_b128 v62, v[56:59]
    buffer_load_dwordx4 v[16:19], v74, s[48:51], 0 offen
    buffer_load_dwordx4 v[20:23], v75, s[48:51], 0 offen
    buffer_load_dwordx4 v[32:35], v7, s[52:55], 0 offen
    buffer_load_dwordx4 v[36:39], v7, s[52:55], 0 offen offset:16
    v_lshrrev_b32 v8, 6, v8
    v_lshrrev_b32 v9, 6, v9
    v_lshrrev_b32 v10, 6, v10
    v_lshrrev_b32 v11, 6, v11
    v_lshrrev_b32 v12, 6, v12
    v_lshrrev_b32 v13, 6, v13
    v_lshrrev_b32 v14, 6, v14
    v_lshrrev_b32 v15, 6, v15
    v_lshlrev_b32 v77, 4, v1
    s_waitcnt lgkmcnt(0)
    s_barrier
    ds_read_b128 v[72:75], v77 offset:0
    ds_read_b128 v[206:209], v151
    ds_read_b128 v[210:213], v151 offset:64
    ds_read_b64_tr_b16 v[96:97], v150 offset:0
    ds_read_b64_tr_b16 v[98:99], v150 offset:512
    ds_read_b64_tr_b16 v[100:101], v150 offset:4096
    ds_read_b64_tr_b16 v[102:103], v150 offset:4608
    s_waitcnt lgkmcnt(6)
    v_add_u32 v89, v72, v73
    v_add_u32 v90, v89, v74
    v_add_u32 v62, v90, v75
    v_mov_b32 v63, v62
    ds_read_b64_tr_b16 v[104:105], v214 offset:0
    ds_read_b64_tr_b16 v[106:107], v214 offset:512
    v_add_u32_dpp v62, v62, v62 row_shr:1 row_mask:0xf bank_mask:0xf
    ds_read_b64_tr_b16 v[108:109], v214 offset:4096
    ds_read_b64_tr_b16 v[110:111], v214 offset:4608
    v_add_u32_dpp v62, v62, v62 row_shr:2 row_mask:0xf bank_mask:0xf
    ds_read_b64_tr_b16 v[112:113], v150 offset:8192
    ds_read_b64_tr_b16 v[114:115], v150 offset:8704
    v_add_u32_dpp v62, v62, v62 row_shr:4 row_mask:0xf bank_mask:0xf
    ds_read_b64_tr_b16 v[116:117], v150 offset:12288
    ds_read_b64_tr_b16 v[118:119], v150 offset:12800
    v_add_u32_dpp v62, v62, v62 row_shr:8 row_mask:0xf bank_mask:0xf
    ds_read_b64_tr_b16 v[120:121], v214 offset:8192
    ds_read_b64_tr_b16 v[122:123], v214 offset:8704
    v_add_u32_dpp v62, v62, v62 row_bcast:15 row_mask:0xa bank_mask:0xf
    ds_read_b64_tr_b16 v[124:125], v214 offset:12288
    ds_read_b64_tr_b16 v[126:127], v214 offset:12800
    v_add_u32_dpp v62, v62, v62 row_bcast:31 row_mask:0xc bank_mask:0xf
    v_sub_u32 v88, v62, v63
    v_add_u32 v91, v88, v90
    v_add_u32 v90, v88, v89
    v_add_u32 v89, v88, v72
    ds_write_b128 v77, v[88:91] offset:1024
    ds_read_b32 v64, v64 offset:1024
    ds_read_b32 v65, v65 offset:1024
    ds_read_b32 v66, v66 offset:1024
    ds_read_b32 v67, v67 offset:1024
    ds_read_b32 v68, v68 offset:1024
    ds_read_b32 v69, v69 offset:1024
    ds_read_b32 v70, v70 offset:1024
    ds_read_b32 v71, v71 offset:1024
    v_lshl_or_b32 v92, v72, 16, v88
    v_lshl_or_b32 v93, v73, 16, v89
    v_lshl_or_b32 v94, v74, 16, v90
    v_lshl_or_b32 v95, v75, 16, v91
    s_waitcnt lgkmcnt(9)
    v_mfma_f32_16x16x32_bf16 v[158:161], v[96:99], v[206:209], 0
    v_mfma_f32_16x16x32_bf16 v[162:165], v[104:107], v[206:209], 0
    v_mfma_f32_16x16x32_bf16 v[166:169], v[112:115], v[206:209], 0
    v_mfma_f32_16x16x32_bf16 v[170:173], v[120:123], v[206:209], 0
    v_mfma_f32_16x16x32_bf16 v[158:161], v[100:103], v[210:213], v[158:161]
    v_mfma_f32_16x16x32_bf16 v[162:165], v[108:111], v[210:213], v[162:165]
    v_mfma_f32_16x16x32_bf16 v[166:169], v[116:119], v[210:213], v[166:169]
    v_mfma_f32_16x16x32_bf16 v[170:173], v[124:127], v[210:213], v[170:173]
    v_and_b32 v91, 127, v0
    v_lshlrev_b32 v91, 2, v91
    s_mov_b32 s24, s16
    s_and_b32 s25, s17, 0xffff
    s_or_b32 s25, s25, 0x1000000
    s_mov_b32 s26, 12501
    s_mov_b32 s27, 0x20000
    s_mov_b32 s36, s82
    s_and_b32 s37, s83, 0xffff
    s_mov_b32 s38, 1600000
    s_mov_b32 s39, 0x20000
    s_mov_b32 s40, 79712
    v_mul_f32 v158, 0xbfb8aa3b, v158
    v_mul_f32 v162, 0xbfb8aa3b, v162
    v_mul_f32 v159, 0xbfb8aa3b, v159
    v_mul_f32 v163, 0xbfb8aa3b, v163
    v_mul_f32 v160, 0xbfb8aa3b, v160
    v_mul_f32 v164, 0xbfb8aa3b, v164
    v_mul_f32 v161, 0xbfb8aa3b, v161
    v_mul_f32 v165, 0xbfb8aa3b, v165
    v_med3_f32 v158, v158, v4, -v4
    v_med3_f32 v162, v162, v4, -v4
    v_med3_f32 v159, v159, v4, -v4
    v_med3_f32 v163, v163, v4, -v4
    v_med3_f32 v160, v160, v4, -v4
    v_med3_f32 v164, v164, v4, -v4
    v_med3_f32 v161, v161, v4, -v4
    v_med3_f32 v165, v165, v4, -v4
    v_cvt_pk_bf16_f32 v78, v166, v166
    v_cvt_pk_bf16_f32 v79, v170, v170
    v_cvt_pk_bf16_f32 v40, v158, v159
    v_cvt_pk_bf16_f32 v44, v162, v163
    v_cvt_pk_bf16_f32 v41, v160, v161
    v_cvt_pk_bf16_f32 v45, v164, v165
    v_perm_b32 v42, v168, v78, s56
    v_perm_b32 v46, v172, v79, s56
    v_perm_b32 v43, v169, v167, s57
    v_perm_b32 v47, v173, v171, s57
    v_cndmask_b32 v40, v40, v5, vcc
    v_cndmask_b32 v44, v44, v5, vcc
    v_cndmask_b32 v41, v41, v5, vcc
    v_cndmask_b32 v45, v45, v5, vcc
    buffer_store_dwordx4 v[40:43], v60, s[28:31], 0 offen offset:0 sc1
    buffer_store_dwordx4 v[44:47], v60, s[28:31], 0 offen offset:64 sc1
    global_load_dwordx4 v[48:51], v215, s[72:73]
    global_load_dwordx4 v[52:55], v215, s[78:79]
    global_load_dword v56, v91, s[76:77]
    s_add_u32 s32, s16, 0x310000
    s_addc_u32 s33, s17, 0
    s_and_b32 s33, s33, 0xffff
    s_mov_b32 s34, 10227712
    s_mov_b32 s35, 0x20000
    s_mul_i32 s41, s2, 37760
    s_add_u32 s41, s41, 0x399000
    s_add_u32 s88, s16, s41
    s_addc_u32 s89, s17, 0
    s_and_b32 s89, s89, 0xffff
    s_mov_b32 s90, 37536
    s_mov_b32 s91, 0x20000
    s_waitcnt vmcnt(7)
    v_lshl_or_b32 v16, v16, 8, v8
    v_lshl_or_b32 v17, v17, 8, v9
    v_lshl_or_b32 v18, v18, 8, v10
    v_lshl_or_b32 v19, v19, 8, v11
    v_lshl_or_b32 v20, v20, 8, v12
    v_lshl_or_b32 v21, v21, 8, v13
    v_lshl_or_b32 v22, v22, 8, v14
    v_lshl_or_b32 v23, v23, 8, v15
    s_waitcnt lgkmcnt(7)
    v_add_u32 v64, v64, v80
    v_mad_u32_u24 v64, v64, 12, s40
    s_waitcnt lgkmcnt(6)
    v_add_u32 v65, v65, v81
    v_mad_u32_u24 v65, v65, 12, s40
    s_waitcnt lgkmcnt(5)
    v_add_u32 v66, v66, v82
    v_mad_u32_u24 v66, v66, 12, s40
    s_waitcnt lgkmcnt(4)
    v_add_u32 v67, v67, v83
    v_mad_u32_u24 v67, v67, 12, s40
    s_waitcnt lgkmcnt(3)
    v_add_u32 v68, v68, v84
    v_mad_u32_u24 v68, v68, 12, s40
    s_waitcnt lgkmcnt(2)
    v_add_u32 v69, v69, v85
    v_mad_u32_u24 v69, v69, 12, s40
    s_waitcnt lgkmcnt(1)
    v_add_u32 v70, v70, v86
    v_mad_u32_u24 v70, v70, 12, s40
    s_waitcnt lgkmcnt(0)
    v_add_u32 v71, v71, v87
    v_mad_u32_u24 v71, v71, 12, s40
    s_mov_b64 exec, s[92:93]
    ds_write_b32 v64, v16 offset:8
    ds_write2_b32 v64, v24, v25 offset0:0 offset1:1
    ds_write_b32 v65, v17 offset:8
    ds_write2_b32 v65, v26, v27 offset0:0 offset1:1
    ds_write_b32 v66, v18 offset:8
    ds_write2_b32 v66, v28, v29 offset0:0 offset1:1
    ds_write_b32 v67, v19 offset:8
    ds_write2_b32 v67, v30, v31 offset0:0 offset1:1
    s_mov_b64 exec, s[94:95]
    ds_write_b32 v68, v20 offset:8
    ds_write_b32 v69, v21 offset:8
    ds_write_b32 v70, v22 offset:8
    ds_write_b32 v71, v23 offset:8
    s_waitcnt vmcnt(5)
    ds_write2_b32 v68, v32, v33 offset0:0 offset1:1
    ds_write2_b32 v69, v34, v35 offset0:0 offset1:1
    ds_write2_b32 v70, v36, v37 offset0:0 offset1:1
    ds_write2_b32 v71, v38, v39 offset0:0 offset1:1
    s_mov_b64 exec, -1
    s_movk_i32 s14, 298
    v_cmp_gt_u32_e64 s[14:15], s14, v0
    v_add_u32 v63, 79712, v61
    v_add_u32 v91, 158592, v91
    s_movk_i32 s44, 0x2000
    s_movk_i32 s45, 0x4000
    s_movk_i32 s46, 0x6000
    s_mov_b32 s47, 0x8000
    v_cmp_gt_u32 vcc, 128, v0
    global_load_dword v64, v217, s[84:85] sc1
    s_waitcnt lgkmcnt(0)
    s_barrier
    ds_read_b128 v[8:11], v63 offset:0
    ds_read_b128 v[12:15], v63 offset:8192
    ds_read_b128 v[16:19], v63 offset:16384
    ds_read_b128 v[20:23], v63 offset:24576
    s_mov_b64 exec, s[14:15]
    ds_read_b128 v[24:27], v63 offset:32768
    s_mov_b64 exec, -1
    v_mov_b32 v28, 0
    v_mov_b32 v29, 0
    v_mov_b32 v30, 0
    v_mov_b32 v31, 0
    s_waitcnt lgkmcnt(4)
    buffer_store_dwordx4 v[8:11], v61, s[88:91], 0 offen sc1
    s_waitcnt lgkmcnt(3)
    buffer_store_dwordx4 v[12:15], v61, s[88:91], s44 offen sc1
    s_waitcnt lgkmcnt(2)
    buffer_store_dwordx4 v[16:19], v61, s[88:91], s45 offen sc1
    s_waitcnt lgkmcnt(1)
    buffer_store_dwordx4 v[20:23], v61, s[88:91], s46 offen sc1
    s_mov_b64 exec, s[14:15]
    s_waitcnt lgkmcnt(0)
    buffer_store_dwordx4 v[24:27], v61, s[88:91], s47 offen sc1
    s_mov_b64 exec, vcc
    ds_write_b128 v61, v[28:31]
    s_mov_b64 exec, -1
    s_waitcnt vmcnt(5)
    ds_write_b128 v63, v[48:51]
    ds_write_b128 v63, v[52:55] offset:8192
    ds_write_b32 v91, v56
    v_add_u32 v150, -43008, v150
    v_add_u32 v214, -43008, v214
    v_lshl_add_u32 v152, v2, 2, v3
    v_lshlrev_b32 v152, 1, v152
    v_add_u32 v152, 158592, v152
    s_movk_i32 s40, 272
    s_lshl_b32 s41, s19, 7
    s_add_u32 s41, s41, 122720
    v_mad_u32_u24 v153, v156, s40, 0
    v_lshl_add_u32 v153, v3, 4, v153
    v_add_u32 v153, s41, v153
    v_cmp_gt_u32_e64 s[14:15], 49, v156
    s_mov_b32 s5, 0
    s_mov_b32 s59, 132
    s_mov_b32 s62, 0x22221111
    s_mov_b32 s63, 0x88884444
    s_mov_b32 s10, 0x21800000
    s_mov_b32 s11, 0x21800000
    s_mov_b32 s6, 0xbfb8aa3b
    s_mov_b32 s7, 0xbfb8aa3b
    v_mov_b32 v148, 0xc2700000
    v_mov_b32 v149, 0xc2700000
    v_and_b32 v5, 1, v155
    v_lshlrev_b32 v5, 4, v5
    v_mov_b32 v6, 0x3f80
    v_lshlrev_b32 v5, v5, v6
    v_cmp_eq_u32 vcc, v3, v154
    v_cmp_gt_u32_e64 s[52:53], 2, v155
    v_cmp_le_u32_e64 s[54:55], 2, v155
    v_mov_b32 v6, 160
    v_cndmask_b32 v5, 0, v5, vcc
    v_cndmask_b32_e64 v157, 0, v6, s[62:63]
    v_mov_b32 v216, 4
    v_cndmask_b32_e64 v130, 0, v5, s[52:53]
    v_cndmask_b32_e64 v131, 0, v5, s[54:55]
    v_lshlrev_b32 v145, 4, v2
    v_cndmask_b32_e64 v134, 0, v5, s[52:53]
    v_cndmask_b32_e64 v135, 0, v5, s[54:55]
    v_lshlrev_b32 v147, 4, v2
    s_lshl_b32 s41, s13, 3
    v_mul_u32_u24 v4, 2176, v3
    v_add_u32 v4, s41, v4
    s_mul_i32 s40, s3, 69632
    s_add_u32 s41, s40, 8704
    s_add_u32 s42, s40, 17408
    s_add_u32 s43, s40, 26112
    s_add_u32 s44, s40, 34816
    s_add_u32 s45, s40, 43520
    s_add_u32 s46, s40, 52224
    s_add_u32 s47, s40, 60928
    s_lshl_b32 s48, s3, 5
    v_add_u32 v5, s48, v3
    s_mov_b32 s49, 37760
    v_mul_lo_u32 v5, v5, s49
    v_mad_u32_u24 v5, v2, 12, v5
    v_add_u32 v5, 561152, v5
    v_add_u32 v6, 16, v2
    s_memrealtime s[50:51]
K_TAGW:
    v_readfirstlane_b32 s96, v64
    s_cmp_lg_u32 s96, 0
    s_cbranch_scc0 K_TAG_RETRY
K_TAGOK:
    s_mul_i32 s48, s96, 0x9e3779b1
    s_and_b32 s48, s48, 0xf000f000
    v_or_b32 v32, s48, v92
    v_mov_b32 v33, s96
    v_or_b32 v34, s48, v93
    v_mov_b32 v35, s96
    v_or_b32 v36, s48, v94
    v_mov_b32 v37, s96
    v_or_b32 v38, s48, v95
    v_mov_b32 v39, s96
    v_lshlrev_b32 v40, 5, v1
    s_mul_i32 s49, s2, 2176
    s_cmp_lg_u32 s3, 0
    s_waitcnt vmcnt(0) lgkmcnt(0)
    s_barrier
    s_cbranch_scc1 K_NOPUB
    buffer_store_dwordx4 v[32:35], v40, s[32:35], s49 offen sc1
    buffer_store_dwordx4 v[36:39], v40, s[32:35], s49 offen offset:16 sc1
K_NOPUB:
    s_cmp_lg_u32 s3, 7
    s_cbranch_scc1 K_NOTLB2
    v_mul_u32_u24 v8, 604160, v1
    v_add_u32 v8, 3772288, v8
    s_mov_b64 exec, 0x1ffff
    global_load_dword v215, v8, s[16:17]
    s_mov_b64 exec, -1
K_NOTLB2:
    ds_read_b64_tr_b16 v[96:97], v150 offset:0
    ds_read_b64_tr_b16 v[98:99], v150 offset:512
    ds_read_b64_tr_b16 v[100:101], v150 offset:4096
    ds_read_b64_tr_b16 v[102:103], v150 offset:4608
    ds_read_b64_tr_b16 v[104:105], v214 offset:0
    ds_read_b64_tr_b16 v[106:107], v214 offset:512
    ds_read_b64_tr_b16 v[108:109], v214 offset:4096
    ds_read_b64_tr_b16 v[110:111], v214 offset:4608
    ds_read_b64_tr_b16 v[112:113], v150 offset:8192
    ds_read_b64_tr_b16 v[114:115], v150 offset:8704
    ds_read_b64_tr_b16 v[116:117], v150 offset:12288
    ds_read_b64_tr_b16 v[118:119], v150 offset:12800
    ds_read_b64_tr_b16 v[120:121], v214 offset:8192
    ds_read_b64_tr_b16 v[122:123], v214 offset:8704
    ds_read_b64_tr_b16 v[124:125], v214 offset:12288
    ds_read_b64_tr_b16 v[126:127], v214 offset:12800
    ds_read_u16 v136, v152
    ds_read_u16 v137, v152 offset:128
    ds_read_u16 v138, v152 offset:256
    ds_read_u16 v139, v152 offset:384
    s_mov_b32 s49, 0xf000f000
    s_waitcnt lgkmcnt(4)
    v_mfma_f32_16x16x32_bf16 v[158:161], v[96:99], v[206:209], 0
    v_mfma_f32_16x16x32_bf16 v[162:165], v[104:107], v[206:209], 0
    v_mfma_f32_16x16x32_bf16 v[166:169], v[112:115], v[206:209], 0
    v_mfma_f32_16x16x32_bf16 v[170:173], v[120:123], v[206:209], 0
    v_mfma_f32_16x16x32_bf16 v[158:161], v[100:103], v[210:213], v[158:161]
    v_mfma_f32_16x16x32_bf16 v[162:165], v[108:111], v[210:213], v[162:165]
    v_mfma_f32_16x16x32_bf16 v[166:169], v[116:119], v[210:213], v[166:169]
    v_mfma_f32_16x16x32_bf16 v[170:173], v[124:127], v[210:213], v[170:173]
    s_waitcnt lgkmcnt(0)
    v_lshlrev_b32 v136, 16, v136
    v_lshlrev_b32 v137, 16, v137
    v_lshlrev_b32 v138, 16, v138
    v_lshlrev_b32 v139, 16, v139
    v_mul_f32 v136, 0xbfb8aa3b, v136
    v_mul_f32 v137, 0xbfb8aa3b, v137
    v_mul_f32 v138, 0xbfb8aa3b, v138
    v_mul_f32 v139, 0xbfb8aa3b, v139
    v_cvt_pk_bf16_f32 v140, v136, v137
    v_cvt_pk_bf16_f32 v141, v138, v139
    v_mov_b32 v84, s96
    v_mov_b32 v85, s48
    s_mov_b64 exec, s[14:15]
    ds_write_b128 v153, v[166:169] offset:13328
    ds_write_b128 v153, v[170:173] offset:13392
    v_pk_fma_f32 v[158:159], v[158:159], s[6:7], v[148:149]
    v_pk_fma_f32 v[160:161], v[160:161], s[6:7], v[148:149]
    v_pk_fma_f32 v[162:163], v[162:163], s[6:7], v[148:149]
    v_pk_fma_f32 v[164:165], v[164:165], s[6:7], v[148:149]
    ds_write_b128 v153, v[158:161]
    ds_write_b128 v153, v[162:165] offset:64
    s_mov_b64 exec, -1
    v_pk_mov_b32 v[8:9], v[140:141], v[140:141] op_sel:[0,1]
    v_pk_mov_b32 v[14:15], v[140:141], v[140:141] op_sel:[0,1]
    v_pk_mov_b32 v[20:21], v[140:141], v[140:141] op_sel:[0,1]
    v_pk_mov_b32 v[26:27], v[140:141], v[140:141] op_sel:[0,1]
    v_pk_mov_b32 v[32:33], v[140:141], v[140:141] op_sel:[0,1]
    v_pk_mov_b32 v[38:39], v[140:141], v[140:141] op_sel:[0,1]
    v_pk_mov_b32 v[44:45], v[140:141], v[140:141] op_sel:[0,1]
    v_pk_mov_b32 v[50:51], v[140:141], v[140:141] op_sel:[0,1]
    v_pk_mov_b32 v[56:57], v[140:141], v[140:141] op_sel:[0,1]
    v_pk_mov_b32 v[62:63], v[140:141], v[140:141] op_sel:[0,1]
    v_pk_mov_b32 v[158:159], 0, 0
    v_pk_mov_b32 v[160:161], 0, 0
    v_pk_mov_b32 v[162:163], 0, 0
    v_pk_mov_b32 v[164:165], 0, 0
    v_pk_mov_b32 v[166:167], 0, 0
    v_pk_mov_b32 v[168:169], 0, 0
    v_pk_mov_b32 v[170:171], 0, 0
    v_pk_mov_b32 v[172:173], 0, 0
K_POLL:
    buffer_load_dwordx2 v[190:191], v4, s[32:35], s40 offen sc1
    buffer_load_dwordx2 v[192:193], v4, s[32:35], s41 offen sc1
    buffer_load_dwordx2 v[194:195], v4, s[32:35], s42 offen sc1
    buffer_load_dwordx2 v[196:197], v4, s[32:35], s43 offen sc1
    buffer_load_dwordx2 v[198:199], v4, s[32:35], s44 offen sc1
    buffer_load_dwordx2 v[200:201], v4, s[32:35], s45 offen sc1
    buffer_load_dwordx2 v[202:203], v4, s[32:35], s46 offen sc1
    buffer_load_dwordx2 v[204:205], v4, s[32:35], s47 offen sc1
K_POLL_CHECK:
    v_mov_b32 v86, 0
    s_waitcnt vmcnt(7)
    v_xor_b32 v87, v190, v85
    v_xor_b32 v88, v191, v84
    v_and_or_b32 v86, v87, s49, v86
    v_and_b32 v174, 0x0fff0fff, v190
    v_or_b32 v86, v88, v86
    s_waitcnt vmcnt(6)
    v_xor_b32 v87, v192, v85
    v_xor_b32 v88, v193, v84
    v_and_or_b32 v86, v87, s49, v86
    v_and_b32 v175, 0x0fff0fff, v192
    v_or_b32 v86, v88, v86
    s_waitcnt vmcnt(5)
    v_xor_b32 v87, v194, v85
    v_xor_b32 v88, v195, v84
    v_and_or_b32 v86, v87, s49, v86
    v_and_b32 v176, 0x0fff0fff, v194
    v_or_b32 v86, v88, v86
    s_waitcnt vmcnt(4)
    v_xor_b32 v87, v196, v85
    v_xor_b32 v88, v197, v84
    v_and_or_b32 v86, v87, s49, v86
    v_and_b32 v177, 0x0fff0fff, v196
    v_or_b32 v86, v88, v86
    s_waitcnt vmcnt(3)
    v_xor_b32 v87, v198, v85
    v_xor_b32 v88, v199, v84
    v_and_or_b32 v86, v87, s49, v86
    v_and_b32 v178, 0x0fff0fff, v198
    v_or_b32 v86, v88, v86
    s_waitcnt vmcnt(2)
    v_xor_b32 v87, v200, v85
    v_xor_b32 v88, v201, v84
    v_and_or_b32 v86, v87, s49, v86
    v_and_b32 v179, 0x0fff0fff, v200
    v_or_b32 v86, v88, v86
    s_waitcnt vmcnt(1)
    v_xor_b32 v87, v202, v85
    v_xor_b32 v88, v203, v84
    v_and_or_b32 v86, v87, s49, v86
    v_and_b32 v180, 0x0fff0fff, v202
    v_or_b32 v86, v88, v86
    s_waitcnt vmcnt(0)
    v_xor_b32 v87, v204, v85
    v_xor_b32 v88, v205, v84
    v_and_or_b32 v86, v87, s49, v86
    v_and_b32 v181, 0x0fff0fff, v204
    v_or_b32 v86, v88, v86
    v_cmp_ne_u32 vcc, 0, v86
    s_cbranch_vccnz K_POLL_RETRY
K_POLLOK:
    s_mov_b64 exec, 1
    ds_add_u32 v217, v216 offset:328
    s_mov_b64 exec, -1
    v_mad_u32_u16 v182, v174, 12, v5
    v_cmp_gt_u32_sdwa s[80:81], v174, v6 src0_sel:WORD_1 src1_sel:DWORD
    v_add_u32 v5, 151040, v5
    s_mov_b64 exec, s[80:81]
    s_cbranch_execz K_M1L0
    buffer_load_dwordx3 v[58:60], v182, s[32:35], 0 offen offset:192 sc1
K_M1L0:
    s_mov_b64 exec, -1
    v_cmp_gt_u32_sdwa s[64:65], v174, v2 src0_sel:WORD_1 src1_sel:DWORD
    v_mad_u32_u16 v183, v175, 12, v5
    v_cmp_gt_u32_sdwa s[82:83], v175, v6 src0_sel:WORD_1 src1_sel:DWORD
    v_add_u32 v5, 151040, v5
    s_mov_b64 exec, s[82:83]
    s_cbranch_execz K_M1L1
    buffer_load_dwordx3 v[64:66], v183, s[32:35], 0 offen offset:192 sc1
K_M1L1:
    s_mov_b64 exec, -1
    v_cmp_gt_u32_sdwa s[66:67], v175, v2 src0_sel:WORD_1 src1_sel:DWORD
    v_mad_u32_u16 v184, v176, 12, v5
    v_cmp_gt_u32_sdwa s[84:85], v176, v6 src0_sel:WORD_1 src1_sel:DWORD
    v_add_u32 v5, 151040, v5
    s_mov_b64 exec, s[84:85]
    s_cbranch_execz K_M1L2
    buffer_load_dwordx3 v[68:70], v184, s[32:35], 0 offen offset:192 sc1
K_M1L2:
    s_mov_b64 exec, -1
    v_cmp_gt_u32_sdwa s[68:69], v176, v2 src0_sel:WORD_1 src1_sel:DWORD
    v_mad_u32_u16 v185, v177, 12, v5
    v_cmp_gt_u32_sdwa s[86:87], v177, v6 src0_sel:WORD_1 src1_sel:DWORD
    v_add_u32 v5, 151040, v5
    s_mov_b64 exec, s[86:87]
    s_cbranch_execz K_M1L3
    buffer_load_dwordx3 v[72:74], v185, s[32:35], 0 offen offset:192 sc1
K_M1L3:
    s_mov_b64 exec, -1
    v_cmp_gt_u32_sdwa s[70:71], v177, v2 src0_sel:WORD_1 src1_sel:DWORD
    v_mad_u32_u16 v186, v178, 12, v5
    v_cmp_gt_u32_sdwa s[88:89], v178, v6 src0_sel:WORD_1 src1_sel:DWORD
    v_add_u32 v5, 151040, v5
    s_mov_b64 exec, s[88:89]
    s_cbranch_execz K_M1L4
    buffer_load_dwordx3 v[76:78], v186, s[32:35], 0 offen offset:192 sc1
K_M1L4:
    s_mov_b64 exec, -1
    v_cmp_gt_u32_sdwa s[72:73], v178, v2 src0_sel:WORD_1 src1_sel:DWORD
    v_mad_u32_u16 v187, v179, 12, v5
    v_cmp_gt_u32_sdwa s[90:91], v179, v6 src0_sel:WORD_1 src1_sel:DWORD
    v_add_u32 v5, 151040, v5
    s_mov_b64 exec, s[90:91]
    s_cbranch_execz K_M1L5
    buffer_load_dwordx3 v[80:82], v187, s[32:35], 0 offen offset:192 sc1
K_M1L5:
    s_mov_b64 exec, -1
    v_cmp_gt_u32_sdwa s[74:75], v179, v2 src0_sel:WORD_1 src1_sel:DWORD
    v_mad_u32_u16 v188, v180, 12, v5
    v_cmp_gt_u32_sdwa s[92:93], v180, v6 src0_sel:WORD_1 src1_sel:DWORD
    v_add_u32 v5, 151040, v5
    s_mov_b64 exec, s[92:93]
    s_cbranch_execz K_M1L6
    buffer_load_dwordx3 v[84:86], v188, s[32:35], 0 offen offset:192 sc1
K_M1L6:
    s_mov_b64 exec, -1
    v_cmp_gt_u32_sdwa s[76:77], v180, v2 src0_sel:WORD_1 src1_sel:DWORD
    v_mad_u32_u16 v189, v181, 12, v5
    v_cmp_gt_u32_sdwa s[94:95], v181, v6 src0_sel:WORD_1 src1_sel:DWORD
    s_mov_b64 exec, s[94:95]
    s_cbranch_execz K_M1L7
    buffer_load_dwordx3 v[88:90], v189, s[32:35], 0 offen offset:192 sc1
K_M1L7:
    s_mov_b64 exec, -1
    v_cmp_gt_u32_sdwa s[78:79], v181, v2 src0_sel:WORD_1 src1_sel:DWORD
    s_mov_b64 exec, s[64:65]
    buffer_load_dwordx3 v[10:12], v182, s[32:35], 0 offen sc1
    s_mov_b64 exec, s[66:67]
    buffer_load_dwordx3 v[16:18], v183, s[32:35], 0 offen sc1
    s_mov_b64 exec, s[68:69]
    buffer_load_dwordx3 v[22:24], v184, s[32:35], 0 offen sc1
    s_mov_b64 exec, s[70:71]
    buffer_load_dwordx3 v[28:30], v185, s[32:35], 0 offen sc1
    s_mov_b64 exec, s[72:73]
    buffer_load_dwordx3 v[34:36], v186, s[32:35], 0 offen sc1
    s_mov_b64 exec, s[74:75]
    buffer_load_dwordx3 v[40:42], v187, s[32:35], 0 offen sc1
    s_mov_b64 exec, s[76:77]
    buffer_load_dwordx3 v[46:48], v188, s[32:35], 0 offen sc1
    s_mov_b64 exec, s[78:79]
    buffer_load_dwordx3 v[52:54], v189, s[32:35], 0 offen sc1
    s_mov_b64 exec, -1
    v_max3_u32 v4, v174, v175, v176
    v_max3_u32 v5, v177, v178, v179
    v_max3_u32 v4, v4, v180, v181
    v_max_u32 v4, v4, v5
    v_lshrrev_b32 v214, 16, v4
    s_waitcnt vmcnt(8)
    s_mov_b64 exec, s[80:81]
    s_cbranch_execz K_M1A0
    v_and_b32 v198, 0xfc, v60
    ds_add_rtn_u32 v61, v198, v216 offset:0
K_M1A0:
    s_mov_b64 exec, s[82:83]
    s_cbranch_execz K_M1A1
    v_and_b32 v199, 0xfc, v66
    ds_add_rtn_u32 v67, v199, v216 offset:0
K_M1A1:
    s_mov_b64 exec, s[84:85]
    s_cbranch_execz K_M1A2
    v_and_b32 v200, 0xfc, v70
    ds_add_rtn_u32 v71, v200, v216 offset:0
K_M1A2:
    s_mov_b64 exec, s[86:87]
    s_cbranch_execz K_M1A3
    v_and_b32 v201, 0xfc, v74
    ds_add_rtn_u32 v75, v201, v216 offset:0
K_M1A3:
    s_mov_b64 exec, s[88:89]
    s_cbranch_execz K_M1A4
    v_and_b32 v202, 0xfc, v78
    ds_add_rtn_u32 v79, v202, v216 offset:0
K_M1A4:
    s_mov_b64 exec, s[90:91]
    s_cbranch_execz K_M1A5
    v_and_b32 v203, 0xfc, v82
    ds_add_rtn_u32 v83, v203, v216 offset:0
K_M1A5:
    s_mov_b64 exec, s[92:93]
    s_cbranch_execz K_M1A6
    v_and_b32 v204, 0xfc, v86
    ds_add_rtn_u32 v87, v204, v216 offset:0
K_M1A6:
    s_mov_b64 exec, s[94:95]
    s_cbranch_execz K_M1A7
    v_and_b32 v205, 0xfc, v90
    ds_add_rtn_u32 v91, v205, v216 offset:0
K_M1A7:
    s_waitcnt vmcnt(7)
    s_mov_b64 exec, s[64:65]
    v_and_b32 v190, 0xfc, v12
    ds_add_rtn_u32 v13, v190, v216 offset:0
    s_waitcnt vmcnt(6)
    s_mov_b64 exec, s[66:67]
    v_and_b32 v191, 0xfc, v18
    ds_add_rtn_u32 v19, v191, v216 offset:0
    s_waitcnt lgkmcnt(2)
    s_mov_b64 exec, s[80:81]
    s_cbranch_execz K_M1W0
    v_min_u32 v61, 512, v61
    v_mad_u32_u24 v198, v198, s59, v61
    v_lshrrev_b32 v60, 8, v60
    v_add_u32 v61, v198, v198
    ds_write_b32 v198, v60 offset:53824
    ds_write_b64 v61, v[58:59] offset:2048
K_M1W0:
    s_mov_b64 exec, s[82:83]
    s_cbranch_execz K_M1W1
    v_min_u32 v67, 512, v67
    v_mad_u32_u24 v199, v199, s59, v67
    v_lshrrev_b32 v66, 8, v66
    v_add_u32 v67, v199, v199
    ds_write_b32 v199, v66 offset:53824
    ds_write_b64 v67, v[64:65] offset:2048
K_M1W1:
    s_mov_b64 exec, s[84:85]
    s_cbranch_execz K_M1W2
    v_min_u32 v71, 512, v71
    v_mad_u32_u24 v200, v200, s59, v71
    v_lshrrev_b32 v70, 8, v70
    v_add_u32 v71, v200, v200
    ds_write_b32 v200, v70 offset:53824
    ds_write_b64 v71, v[68:69] offset:2048
K_M1W2:
    s_mov_b64 exec, s[86:87]
    s_cbranch_execz K_M1W3
    v_min_u32 v75, 512, v75
    v_mad_u32_u24 v201, v201, s59, v75
    v_lshrrev_b32 v74, 8, v74
    v_add_u32 v75, v201, v201
    ds_write_b32 v201, v74 offset:53824
    ds_write_b64 v75, v[72:73] offset:2048
K_M1W3:
    s_mov_b64 exec, s[88:89]
    s_cbranch_execz K_M1W4
    v_min_u32 v79, 512, v79
    v_mad_u32_u24 v202, v202, s59, v79
    v_lshrrev_b32 v78, 8, v78
    v_add_u32 v79, v202, v202
    ds_write_b32 v202, v78 offset:53824
    ds_write_b64 v79, v[76:77] offset:2048
K_M1W4:
    s_mov_b64 exec, s[90:91]
    s_cbranch_execz K_M1W5
    v_min_u32 v83, 512, v83
    v_mad_u32_u24 v203, v203, s59, v83
    v_lshrrev_b32 v82, 8, v82
    v_add_u32 v83, v203, v203
    ds_write_b32 v203, v82 offset:53824
    ds_write_b64 v83, v[80:81] offset:2048
K_M1W5:
    s_mov_b64 exec, s[92:93]
    s_cbranch_execz K_M1W6
    v_min_u32 v87, 512, v87
    v_mad_u32_u24 v204, v204, s59, v87
    v_lshrrev_b32 v86, 8, v86
    v_add_u32 v87, v204, v204
    ds_write_b32 v204, v86 offset:53824
    ds_write_b64 v87, v[84:85] offset:2048
K_M1W6:
    s_mov_b64 exec, s[94:95]
    s_cbranch_execz K_M1W7
    v_min_u32 v91, 512, v91
    v_mad_u32_u24 v205, v205, s59, v91
    v_lshrrev_b32 v90, 8, v90
    v_add_u32 v91, v205, v205
    ds_write_b32 v205, v90 offset:53824
    ds_write_b64 v91, v[88:89] offset:2048
K_M1W7:
    s_waitcnt vmcnt(5)
    s_mov_b64 exec, s[68:69]
    v_and_b32 v192, 0xfc, v24
    ds_add_rtn_u32 v25, v192, v216 offset:0
    s_mov_b64 exec, s[64:65]
    s_waitcnt lgkmcnt(1)
    v_min_u32 v13, 512, v13
    v_mad_u32_u24 v190, v190, s59, v13
    v_lshrrev_b32 v12, 8, v12
    v_add_u32 v13, v190, v190
    ds_write_b32 v190, v12 offset:53824
    ds_write_b64 v13, v[10:11] offset:2048
    s_mov_b64 exec, s[66:67]
    v_min_u32 v19, 512, v19
    v_mad_u32_u24 v191, v191, s59, v19
    v_lshrrev_b32 v18, 8, v18
    v_add_u32 v19, v191, v191
    ds_write_b32 v191, v18 offset:53824
    ds_write_b64 v19, v[16:17] offset:2048
    s_waitcnt vmcnt(4)
    s_mov_b64 exec, s[70:71]
    v_and_b32 v193, 0xfc, v30
    ds_add_rtn_u32 v31, v193, v216 offset:0
    s_mov_b64 exec, s[68:69]
    s_waitcnt lgkmcnt(5)
    v_min_u32 v25, 512, v25
    v_mad_u32_u24 v192, v192, s59, v25
    v_lshrrev_b32 v24, 8, v24
    v_add_u32 v25, v192, v192
    ds_write_b32 v192, v24 offset:53824
    ds_write_b64 v25, v[22:23] offset:2048
    s_waitcnt vmcnt(3)
    s_mov_b64 exec, s[72:73]
    v_and_b32 v194, 0xfc, v36
    ds_add_rtn_u32 v37, v194, v216 offset:0
    s_mov_b64 exec, s[70:71]
    s_waitcnt lgkmcnt(3)
    v_min_u32 v31, 512, v31
    v_mad_u32_u24 v193, v193, s59, v31
    v_lshrrev_b32 v30, 8, v30
    v_add_u32 v31, v193, v193
    ds_write_b32 v193, v30 offset:53824
    ds_write_b64 v31, v[28:29] offset:2048
    s_waitcnt vmcnt(2)
    s_mov_b64 exec, s[74:75]
    v_and_b32 v195, 0xfc, v42
    ds_add_rtn_u32 v43, v195, v216 offset:0
    s_mov_b64 exec, s[72:73]
    s_waitcnt lgkmcnt(3)
    v_min_u32 v37, 512, v37
    v_mad_u32_u24 v194, v194, s59, v37
    v_lshrrev_b32 v36, 8, v36
    v_add_u32 v37, v194, v194
    ds_write_b32 v194, v36 offset:53824
    ds_write_b64 v37, v[34:35] offset:2048
    s_waitcnt vmcnt(1)
    s_mov_b64 exec, s[76:77]
    v_and_b32 v196, 0xfc, v48
    ds_add_rtn_u32 v49, v196, v216 offset:0
    s_mov_b64 exec, -1
    ds_read_b32 v7, v217 offset:328
    s_mov_b64 exec, s[74:75]
    s_waitcnt lgkmcnt(4)
    v_min_u32 v43, 512, v43
    v_mad_u32_u24 v195, v195, s59, v43
    v_lshrrev_b32 v42, 8, v42
    v_add_u32 v43, v195, v195
    ds_write_b32 v195, v42 offset:53824
    ds_write_b64 v43, v[40:41] offset:2048
    s_waitcnt vmcnt(0)
    s_mov_b64 exec, s[78:79]
    v_and_b32 v197, 0xfc, v54
    ds_add_rtn_u32 v55, v197, v216 offset:0
    s_mov_b64 exec, -1
    v_cmp_lt_u32 vcc, 32, v214
    s_waitcnt lgkmcnt(3)
    v_readfirstlane_b32 s40, v7
    s_cbranch_vccnz K_LONG_ENTRY
K_PLACED:
    s_cmp_lg_u32 s40, 32
    s_cbranch_scc1 K_NOPF
    s_lshr_b32 s40, s2, 3
    s_mul_i32 s40, s40, 100096
    v_mul_u32_u24 v7, 128, v0
    v_add_u32 v7, s40, v7
    v_cmp_gt_u32 vcc, 352, v0
    s_mov_b64 exec, vcc
    buffer_load_dword v215, v7, s[28:31], 0 offen sc1
K_NOPF:
    s_waitcnt lgkmcnt(0)
    s_barrier
    s_mov_b64 exec, s[76:77]
    v_min_u32 v49, 512, v49
    v_mad_u32_u24 v196, v196, s59, v49
    v_lshrrev_b32 v48, 8, v48
    v_add_u32 v49, v196, v196
    ds_write_b32 v196, v48 offset:53824
    ds_write_b64 v49, v[46:47] offset:2048
    s_mov_b64 exec, s[78:79]
    v_min_u32 v55, 512, v55
    v_mad_u32_u24 v197, v197, s59, v55
    v_lshrrev_b32 v54, 8, v54
    v_add_u32 v55, v197, v197
    ds_write_b32 v197, v54 offset:53824
    ds_write_b64 v55, v[52:53] offset:2048
    s_mov_b64 exec, -1
K_RANK:
    v_lshlrev_b32 v4, 2, v1
    ds_read_b32 v68, v4 offset:0
    v_mov_b32 v5, 0x4000
    ds_write_b32 v4, v5 offset:1280
    s_add_u32 s41, s3, 8
    s_add_u32 s42, s3, 16
    s_add_u32 s43, s3, 24
    s_add_u32 s44, s3, 32
    s_add_u32 s45, s3, 40
    v_cmp_gt_u32_e64 s[52:53], 48, v1
    v_lshl_add_u32 v70, v1, 3, s3
    v_mul_u32_u24 v74, 528, v70
    v_mul_u32_u24 v75, 272, v70
    v_add_u32 v75, 122720, v75
    v_lshlrev_b32 v70, 2, v70
    s_waitcnt lgkmcnt(0)
    v_cmp_lt_u32 vcc, 512, v68
    v_lshl_add_u32 v69, v68, 4, v1
    v_add_u32 v69, 1, v69
    s_cbranch_vccnz K_SLOW_ENTRY
    v_cndmask_b32_e64 v69, 0, v69, s[52:53]
    v_readlane_b32 s50, v68, 48
    v_readlane_b32 s64, v69, s3
    v_readlane_b32 s65, v69, s41
    v_readlane_b32 s66, v69, s42
    v_readlane_b32 s67, v69, s43
    v_readlane_b32 s68, v69, s44
    v_readlane_b32 s69, v69, s45
    s_add_u32 s51, s50, 28
    v_cmp_lt_u32_e64 s[72:73], s64, v69
    v_cmp_lt_u32_e64 s[74:75], s65, v69
    v_cmp_lt_u32_e64 s[76:77], s66, v69
    v_cmp_lt_u32_e64 s[78:79], s67, v69
    v_cmp_lt_u32_e64 s[80:81], s68, v69
    v_cmp_lt_u32_e64 s[82:83], s69, v69
    s_lshr_b32 s51, s51, 5
    v_writelane_b32 v71, s64, 0
    s_bcnt1_i32_b64 s72, s[72:73]
    v_writelane_b32 v71, s65, 1
    s_bcnt1_i32_b64 s74, s[74:75]
    v_writelane_b32 v71, s66, 2
    s_bcnt1_i32_b64 s76, s[76:77]
    v_writelane_b32 v71, s67, 3
    s_bcnt1_i32_b64 s78, s[78:79]
    v_writelane_b32 v71, s68, 4
    s_bcnt1_i32_b64 s80, s[80:81]
    v_writelane_b32 v71, s69, 5
    s_bcnt1_i32_b64 s82, s[82:83]
    s_max_u32 s51, s51, 6
    s_cmp_eq_u32 s50, 0
    s_cselect_b32 s50, 0, s51
    s_mul_i32 s50, s50, 2
    v_writelane_b32 v72, s72, 0
    v_writelane_b32 v72, s74, 1
    v_writelane_b32 v72, s76, 2
    v_writelane_b32 v72, s78, 3
    v_writelane_b32 v72, s80, 4
    v_writelane_b32 v72, s82, 5
    v_lshrrev_b32 v71, 6, v71
    v_add_u32 v72, 4, v72
    v_lshlrev_b32 v73, 3, v72
    v_lshlrev_b32 v76, 2, v72
    s_mov_b64 exec, 63
    ds_write_b64 v73, v[74:75] offset:640
    ds_write_b32 v76, v71 offset:1536
    ds_write_b32 v70, v72 offset:1792
    s_mov_b64 exec, 15
    v_mul_u32_u24 v78, s50, v4
    v_add_u32 v78, 25344, v78
    v_mov_b32 v79, 135776
    v_mov_b32 v77, s50
    v_lshlrev_b32 v5, 3, v1
    ds_write_b64 v5, v[78:79] offset:640
    ds_write_b32 v4, v77 offset:1536
    ds_write_b32 v4, v1 offset:1984
    s_mov_b64 exec, -1
    v_lshlrev_b32 v4, 4, v2
    v_cmp_gt_u32_e64 s[52:53], 13, v2
    s_and_b32 s18, s3, 3
    s_lshl_b32 s18, s18, 1
    s_lshr_b32 s15, s3, 2
    s_add_u32 s18, s18, s15
    s_add_u32 s15, s18, 1
    s_waitcnt lgkmcnt(0)
    s_barrier
    ds_read_b32 v68, v4 offset:1536
    v_mov_b32 v72, 1
    v_mov_b32 v73, 0
    s_waitcnt lgkmcnt(0)
    v_cmp_ne_u32 vcc, 0, v68
    v_add_u32 v68, 1, v68
    v_lshrrev_b32 v68, 1, v68
    s_and_b64 s[44:45], vcc, s[52:53]
    v_max_u32 v68, 6, v68
    v_cndmask_b32_e64 v68, 0, v68, s[44:45]
    v_mov_b32 v69, v68
    s_nop 1
    v_add_u32_dpp v69, v69, v69 row_shr:1 row_mask:0xf bank_mask:0xf
    s_nop 1
    v_add_u32_dpp v69, v69, v69 row_shr:2 row_mask:0xf bank_mask:0xf
    s_nop 1
    v_add_u32_dpp v69, v69, v69 row_shr:4 row_mask:0xf bank_mask:0xf
    s_nop 1
    v_add_u32_dpp v69, v69, v69 row_shr:8 row_mask:0xf bank_mask:0xf
    s_nop 0
    v_readlane_b32 s14, v69, 15
    v_sub_u32 v70, v69, v68
    s_cmp_gt_u32 s14, 496
    s_cbranch_scc1 K_SLOW_ENTRY
    s_mul_i32 s40, s14, s18
    s_mul_i32 s41, s14, s15
    s_lshr_b32 s40, s40, 3
    s_lshr_b32 s41, s41, 3
    s_sub_u32 s4, s41, s40
    s_cmp_eq_u32 s4, 0
    s_cbranch_scc1 K_NOWORK
    v_cmp_ge_u32_e64 s[42:43], s40, v69
    v_subrev_u32 v71, s40, v70
    s_and_b32 s42, s42, 0x1fff
    s_bcnt1_i32_b32 s42, s42
    s_lshl_b32 s46, s42, 5
    v_lshl_add_u32 v154, v3, 3, s46
    v_and_b32 v155, 12, v2
    v_lshl_add_u32 v155, v155, 1, s46
    v_readlane_b32 s43, v70, s42
    ds_read_b64 v[74:75], v154 offset:640
    ds_read_b32 v156, v155 offset:640
    ds_read_b64 v[148:149], v154 offset:672
    v_add_u32 v76, -1, v71
    v_cmp_gt_u32 vcc, 63, v76
    v_lshlrev_b64 v[72:73], v71, v[72:73]
    s_and_b64 vcc, vcc, s[44:45]
    s_sub_u32 s43, s40, s43
    v_cndmask_b32 v72, 0, v72, vcc
    v_cndmask_b32 v73, 0, v73, vcc
    s_mul_i32 s45, s43, 8
    s_lshl_b32 s47, s45, 1
    v_or_b32_dpp v72, v72, v72 row_shr:1 row_mask:0xf bank_mask:0xf
    v_or_b32_dpp v73, v73, v73 row_shr:1 row_mask:0xf bank_mask:0xf
    s_nop 0
    v_or_b32_dpp v72, v72, v72 row_shr:2 row_mask:0xf bank_mask:0xf
    v_or_b32_dpp v73, v73, v73 row_shr:2 row_mask:0xf bank_mask:0xf
    s_nop 0
    v_or_b32_dpp v72, v72, v72 row_shr:4 row_mask:0xf bank_mask:0xf
    v_or_b32_dpp v73, v73, v73 row_shr:4 row_mask:0xf bank_mask:0xf
    s_nop 0
    v_or_b32_dpp v72, v72, v72 row_shr:8 row_mask:0xf bank_mask:0xf
    v_or_b32_dpp v73, v73, v73 row_shr:8 row_mask:0xf bank_mask:0xf
    s_nop 0
    s_add_u32 s45, s45, 53824
    s_add_u32 s47, s47, 2048
    v_readlane_b32 s60, v72, 15
    v_readlane_b32 s61, v73, 15
    s_bfm_b64 s[48:49], s4, 0
    s_waitcnt lgkmcnt(1)
    v_add_u32 v150, s45, v74
    v_add_u32 v75, v75, v145
    s_and_b64 s[60:61], s[60:61], s[48:49]
    ds_read_b32 v144, v150 offset:0
    ds_read_b32 v146, v150 offset:4
    ds_read_b128 v[136:139], v75
    v_lshl_add_u32 v151, v156, 1, s47
    v_mov_b32 v4, 384
    v_mov_b32 v69, v145
    v_mov_b32 v71, v145
    v_mov_b32 v85, v145
    v_mov_b32 v87, v145
    v_mov_b32 v89, v145
    v_mov_b32 v91, v145
    v_mov_b32 v93, v145
    v_mov_b32 v95, v145
    v_cndmask_b32_e64 v151, v4, v151, s[62:63]
    s_waitcnt lgkmcnt(1)
    buffer_load_dwordx4 v[10:13], v[144:145], s[24:27], 0 idxen offen sc1
    buffer_load_dwordx4 v[16:19], v[146:147], s[24:27], 0 idxen offen sc1
    s_bitcmp1_b32 s60, 1
    s_cbranch_scc0 K_PK1
    v_add_u32 v150, 53816, v148
    v_add_u32 v4, v149, v145
    v_add_u32 v154, 32, v154
    v_add_u32 v155, 32, v155
    ds_read_b128 v[140:143], v4
    ds_read_b32 v156, v155 offset:640
    ds_read_b64 v[148:149], v154 offset:672
K_PK1:
    ds_read_b32 v68, v150 offset:8
    ds_read_b32 v70, v150 offset:12
    s_bitcmp1_b32 s60, 2
    s_cbranch_scc0 K_PK2
    v_add_u32 v150, 53808, v148
    v_add_u32 v4, v149, v145
    v_add_u32 v154, 32, v154
    v_add_u32 v155, 32, v155
    ds_read_b128 v[140:143], v4
    ds_read_b32 v156, v155 offset:640
    ds_read_b64 v[148:149], v154 offset:672
K_PK2:
    ds_read_b32 v84, v150 offset:16
    ds_read_b32 v86, v150 offset:20
    s_bitcmp1_b32 s60, 3
    s_cbranch_scc0 K_PK3
    v_add_u32 v150, 53800, v148
    v_add_u32 v4, v149, v145
    v_add_u32 v154, 32, v154
    v_add_u32 v155, 32, v155
    ds_read_b128 v[140:143], v4
    ds_read_b32 v156, v155 offset:640
    ds_read_b64 v[148:149], v154 offset:672
K_PK3:
    ds_read_b32 v88, v150 offset:24
    ds_read_b32 v90, v150 offset:28
    s_bitcmp1_b32 s60, 4
    s_cbranch_scc0 K_PK4
    v_add_u32 v150, 53792, v148
    v_add_u32 v4, v149, v145
    v_add_u32 v154, 32, v154
    v_add_u32 v155, 32, v155
    ds_read_b128 v[140:143], v4
    ds_read_b32 v156, v155 offset:640
    ds_read_b64 v[148:149], v154 offset:672
K_PK4:
    ds_read_b32 v92, v150 offset:32
    ds_read_b32 v94, v150 offset:36
    ds_read_b64 v[128:129], v151 offset:0
    ds_read_b64 v[132:133], v151 offset:8
    s_lshr_b64 s[56:57], s[60:61], 3
    s_mov_b32 s12, s60
    s_bitset1_b64 s[60:61], s4
    s_lshr_b64 s[48:49], s[60:61], 6
    s_or_b64 s[56:57], s[56:57], s[48:49]
    s_lshr_b64 s[48:49], s[60:61], 1
    s_or_b64 s[56:57], s[56:57], s[48:49]
    s_waitcnt lgkmcnt(2)
    buffer_load_dwordx4 v[22:25], v[68:69], s[24:27], 0 idxen offen sc1
    buffer_load_dwordx4 v[28:31], v[70:71], s[24:27], 0 idxen offen sc1
    s_setprio 3
    s_mov_b32 s58, 3
    s_mov_b64 s[54:55], 0
    s_bitset1_b64 s[54:55], 39
    s_bitset1_b64 s[54:55], 51
    s_bitset1_b64 s[54:55], 59
    s_sub_u32 s46, 63, s4
    s_lshr_b64 s[54:55], s[54:55], s46
    s_or_b64 s[56:57], s[56:57], s[54:55]
    s_ff1_i32_b64 s9, s[56:57]
    v_lshlrev_b32 v5, 9, v3
    v_lshl_add_u32 v5, v2, 4, v5
    s_lshl_b32 s45, s42, 11
    s_add_u32 s45, s45, 79712
    s_add_u32 s46, s45, 2048
    v_add_u32 v153, s46, v5
    s_cmp_eq_u32 s43, 0
    s_cbranch_scc1 K_P2
    s_lshl_b32 s45, s3, 11
    s_add_u32 s45, s45, 106336
    s_lshl_b32 s46, 1, s3
    s_lshl_b32 s47, s42, 2
    v_mov_b32 v6, s46
    v_mov_b32 v7, s47
    s_mov_b64 exec, 1
    ds_or_b32 v7, v6 offset:256
    s_mov_b64 exec, -1
K_P2:
    v_add_u32 v152, s45, v5
    v_pk_mov_b32 v[104:105], 0, 0
    v_pk_mov_b32 v[106:107], 0, 0
    v_pk_mov_b32 v[108:109], 0, 0
    v_pk_mov_b32 v[110:111], 0, 0
    v_add_u32 v150, 40, v150
    s_bitcmp1_b32 s12, 5
    s_cbranch_scc0 K_PK5
    v_add_u32 v150, 53824, v148
    v_add_u32 v4, v149, v145
    v_add_u32 v154, 32, v154
    v_add_u32 v155, 32, v155
    ds_read_b128 v[140:143], v4
    ds_read_b32 v156, v155 offset:640
    ds_read_b64 v[148:149], v154 offset:672
K_PK5:
    v_mov_b32 v5, 32
    v_lshrrev_b32 v237, 3, v0
    v_min_u32 v234, 48, v237
    v_lshlrev_b32 v238, 2, v237
    v_lshlrev_b32 v239, 2, v234
    v_and_b32 v236, 7, v0
    v_lshlrev_b32 v235, 5, v236
    v_cmp_gt_u32_e64 s[20:21], 52, v237
    s_movk_i32 s22, 272
    v_mad_u32_u24 v6, v234, s22, v235
    v_add_u32 v6, 136048, v6
    v_mul_u32_u24 v7, 144, v234
    v_lshl_add_u32 v7, v236, 4, v7
    v_add_u32 v7, 149376, v7
    ds_read_b32 v238, v238 offset:1792
    ds_read_b32 v239, v239 offset:0
    ds_read_b128 v[218:221], v6
    ds_read_b128 v[222:225], v6 offset:16
    ds_read_b128 v[230:233], v7
    v_lshlrev_b32 v237, 8, v237
    v_add_u32 v237, s13, v237
    v_lshlrev_b32 v237, 7, v237
    v_lshl_add_u32 v237, v236, 4, v237
    s_waitcnt vmcnt(2) lgkmcnt(0)
    v_mfma_f32_16x16x32_bf16 v[68:71], v[128:131], v[8:11], v[136:139]
    v_mfma_f32_16x16x32_bf16 v[72:75], v[132:135], v[14:17], v[136:139]
    buffer_load_dwordx4 v[34:37], v[84:85], s[24:27], 0 idxen offen sc1
    buffer_load_dwordx4 v[40:43], v[86:87], s[24:27], 0 idxen offen sc1
    buffer_load_dwordx4 v[46:49], v[88:89], s[24:27], 0 idxen offen sc1
    buffer_load_dwordx4 v[52:55], v[90:91], s[24:27], 0 idxen offen sc1
    s_bitcmp1_b32 s12, 1
    s_cbranch_scc0 K_PE1
    s_nop 2
    v_lshlrev_b32 v151, 1, v156
    v_add_u32 v151, 2032, v151
    v_mov_b32 v4, 384
    v_pk_mov_b32 v[136:137], v[140:141], v[140:141] op_sel:[0,1]
    v_pk_mov_b32 v[138:139], v[142:143], v[142:143] op_sel:[0,1]
    v_cndmask_b32_e64 v151, v4, v151, s[62:63]
K_PE1:
    ds_read_b64 v[128:129], v151 offset:16
    ds_read_b64 v[132:133], v151 offset:24
    v_cndmask_b32_e64 v5, 0, v5, s[62:63]
    v_cmp_ne_u32_e64 s[22:23], 0, v239
    v_and_b32 v236, -4, v238
    v_lshl_add_u32 v234, v238, 9, v235
    v_add_u32 v234, 79712, v234
    v_and_b32 v238, 3, v238
    v_lshl_add_u32 v235, v238, 9, v235
    v_add_u32 v235, 106336, v235
    s_and_b64 s[20:21], s[20:21], s[22:23]
    v_lshlrev_b32 v226, 16, v230
    v_and_b32 v227, 0xffff0000, v230
    v_lshlrev_b32 v228, 16, v231
    v_and_b32 v229, 0xffff0000, v231
    v_lshlrev_b32 v230, 16, v232
    v_and_b32 v231, 0xffff0000, v232
    v_lshlrev_b32 v232, 16, v233
    v_and_b32 v233, 0xffff0000, v233
    v_exp_f32 v68, v68
    v_exp_f32 v69, v69
    v_exp_f32 v70, v70
    v_exp_f32 v71, v71
    v_exp_f32 v72, v72
    v_exp_f32 v73, v73
    v_exp_f32 v74, v74
    v_exp_f32 v75, v75
    v_add_u32 v151, v5, v151
    s_waitcnt vmcnt(4) lgkmcnt(0)
    v_mfma_f32_16x16x32_bf16 v[76:79], v[128:131], v[20:23], v[136:139]
    v_mfma_f32_16x16x32_bf16 v[80:83], v[132:135], v[26:29], v[136:139]
    buffer_load_dwordx4 v[58:61], v[92:93], s[24:27], 0 idxen offen sc1
    buffer_load_dwordx4 v[64:67], v[94:95], s[24:27], 0 idxen offen sc1
    s_bitcmp1_b32 s12, 2
    s_cbranch_scc0 K_PE2
    s_nop 2
    v_lshlrev_b32 v151, 1, v156
    v_add_u32 v151, 2048, v151
    v_mov_b32 v4, 384
    v_pk_mov_b32 v[136:137], v[140:141], v[140:141] op_sel:[0,1]
    v_pk_mov_b32 v[138:139], v[142:143], v[142:143] op_sel:[0,1]
    v_cndmask_b32_e64 v151, v4, v151, s[62:63]
K_PE2:
    s_nop 4
    .p2align 3
K_LOOP:
    ds_read_b32 v144, v150 offset:0
    ds_read_b32 v146, v150 offset:4
    ds_read_b64 v[128:129], v151 offset:0
    ds_read_b64 v[132:133], v151 offset:8
    v_pk_add_f32 v[68:69], v[68:69], s[10:11] clamp
    v_pk_add_f32 v[72:73], v[72:73], s[10:11] clamp
    v_exp_f32 v76, v76
    v_pk_mul_f32 v[92:93], v[68:69], v[72:73]
    v_exp_f32 v77, v77
    v_pk_add_f32 v[70:71], v[70:71], s[10:11] clamp
    v_pk_add_f32 v[74:75], v[74:75], s[10:11] clamp
    v_exp_f32 v78, v78
    v_pk_mul_f32 v[94:95], v[70:71], v[74:75]
    v_exp_f32 v79, v79
    v_lshlrev_b64 v[84:85], 16, v[12:13]
    v_exp_f32 v80, v80
    v_lshlrev_b64 v[86:87], 16, v[18:19]
    v_exp_f32 v81, v81
    v_pk_add_f32 v[96:97], v[68:69], v[72:73]
    v_pk_add_f32 v[98:99], v[70:71], v[74:75]
    v_pk_mul_f32 v[100:101], v[72:73], v[84:85]
    v_pk_mul_f32 v[102:103], v[74:75], v[12:13]
    v_pk_fma_f32 v[100:101], v[68:69], v[86:87], v[100:101]
    v_pk_fma_f32 v[102:103], v[70:71], v[18:19], v[102:103]
    s_waitcnt vmcnt(4) lgkmcnt(0)
    buffer_load_dwordx4 v[10:13], v[144:145], s[24:27], 0 idxen offen sc1
    buffer_load_dwordx4 v[16:19], v[146:147], s[24:27], 0 idxen offen sc1
    s_sub_u32 s9, s9, 1
    v_mfma_f32_16x16x32_bf16 v[68:71], v[128:131], v[32:35], v[136:139]
    v_rcp_f32 v92, v92
    v_rcp_f32 v93, v93
    v_mfma_f32_16x16x32_bf16 v[72:75], v[132:135], v[38:41], v[136:139]
    v_rcp_f32 v94, v94
    v_rcp_f32 v95, v95
    v_exp_f32 v82, v82
    v_pk_fma_f32 v[104:105], v[96:97], v[92:93], v[104:105]
    v_exp_f32 v83, v83
    v_pk_fma_f32 v[106:107], v[98:99], v[94:95], v[106:107]
    v_pk_fma_f32 v[108:109], v[100:101], v[92:93], v[108:109]
    v_pk_fma_f32 v[110:111], v[102:103], v[94:95], v[110:111]
    s_cbranch_scc1 K_EV0
K_RET0:
    ds_read_b32 v144, v150 offset:8
    ds_read_b32 v146, v150 offset:12
    ds_read_b64 v[128:129], v151 offset:16
    ds_read_b64 v[132:133], v151 offset:24
    v_pk_add_f32 v[76:77], v[76:77], s[10:11] clamp
    v_pk_add_f32 v[80:81], v[80:81], s[10:11] clamp
    v_exp_f32 v68, v68
    v_pk_mul_f32 v[92:93], v[76:77], v[80:81]
    v_exp_f32 v69, v69
    v_pk_add_f32 v[78:79], v[78:79], s[10:11] clamp
    v_pk_add_f32 v[82:83], v[82:83], s[10:11] clamp
    v_exp_f32 v70, v70
    v_pk_mul_f32 v[94:95], v[78:79], v[82:83]
    v_exp_f32 v71, v71
    v_lshlrev_b64 v[84:85], 16, v[24:25]
    v_exp_f32 v72, v72
    v_lshlrev_b64 v[86:87], 16, v[30:31]
    v_exp_f32 v73, v73
    v_pk_add_f32 v[96:97], v[76:77], v[80:81]
    v_pk_add_f32 v[98:99], v[78:79], v[82:83]
    v_pk_mul_f32 v[100:101], v[80:81], v[84:85]
    v_pk_mul_f32 v[102:103], v[82:83], v[24:25]
    v_pk_fma_f32 v[100:101], v[76:77], v[86:87], v[100:101]
    v_pk_fma_f32 v[102:103], v[78:79], v[30:31], v[102:103]
    s_waitcnt vmcnt(4) lgkmcnt(0)
    buffer_load_dwordx4 v[22:25], v[144:145], s[24:27], 0 idxen offen sc1
    buffer_load_dwordx4 v[28:31], v[146:147], s[24:27], 0 idxen offen sc1
    s_sub_u32 s9, s9, 1
    v_mfma_f32_16x16x32_bf16 v[76:79], v[128:131], v[44:47], v[136:139]
    v_rcp_f32 v92, v92
    v_rcp_f32 v93, v93
    v_mfma_f32_16x16x32_bf16 v[80:83], v[132:135], v[50:53], v[136:139]
    v_rcp_f32 v94, v94
    v_rcp_f32 v95, v95
    v_exp_f32 v74, v74
    v_pk_fma_f32 v[104:105], v[96:97], v[92:93], v[104:105]
    v_exp_f32 v75, v75
    v_pk_fma_f32 v[106:107], v[98:99], v[94:95], v[106:107]
    v_pk_fma_f32 v[108:109], v[100:101], v[92:93], v[108:109]
    v_pk_fma_f32 v[110:111], v[102:103], v[94:95], v[110:111]
    s_cbranch_scc1 K_EV1
K_RET1:
    ds_read_b32 v144, v150 offset:16
    ds_read_b32 v146, v150 offset:20
    ds_read_b64 v[128:129], v151 offset:32
    ds_read_b64 v[132:133], v151 offset:40
    v_pk_add_f32 v[68:69], v[68:69], s[10:11] clamp
    v_pk_add_f32 v[72:73], v[72:73], s[10:11] clamp
    v_exp_f32 v76, v76
    v_pk_mul_f32 v[92:93], v[68:69], v[72:73]
    v_exp_f32 v77, v77
    v_pk_add_f32 v[70:71], v[70:71], s[10:11] clamp
    v_pk_add_f32 v[74:75], v[74:75], s[10:11] clamp
    v_exp_f32 v78, v78
    v_pk_mul_f32 v[94:95], v[70:71], v[74:75]
    v_exp_f32 v79, v79
    v_lshlrev_b64 v[84:85], 16, v[36:37]
    v_exp_f32 v80, v80
    v_lshlrev_b64 v[86:87], 16, v[42:43]
    v_exp_f32 v81, v81
    v_pk_add_f32 v[96:97], v[68:69], v[72:73]
    v_pk_add_f32 v[98:99], v[70:71], v[74:75]
    v_pk_mul_f32 v[100:101], v[72:73], v[84:85]
    v_pk_mul_f32 v[102:103], v[74:75], v[36:37]
    v_pk_fma_f32 v[100:101], v[68:69], v[86:87], v[100:101]
    v_pk_fma_f32 v[102:103], v[70:71], v[42:43], v[102:103]
    s_waitcnt vmcnt(4) lgkmcnt(0)
    buffer_load_dwordx4 v[34:37], v[144:145], s[24:27], 0 idxen offen sc1
    buffer_load_dwordx4 v[40:43], v[146:147], s[24:27], 0 idxen offen sc1
    s_sub_u32 s9, s9, 1
    v_mfma_f32_16x16x32_bf16 v[68:71], v[128:131], v[56:59], v[136:139]
    v_rcp_f32 v92, v92
    v_rcp_f32 v93, v93
    v_mfma_f32_16x16x32_bf16 v[72:75], v[132:135], v[62:65], v[136:139]
    v_rcp_f32 v94, v94
    v_rcp_f32 v95, v95
    v_exp_f32 v82, v82
    v_pk_fma_f32 v[104:105], v[96:97], v[92:93], v[104:105]
    v_exp_f32 v83, v83
    v_pk_fma_f32 v[106:107], v[98:99], v[94:95], v[106:107]
    v_pk_fma_f32 v[108:109], v[100:101], v[92:93], v[108:109]
    v_pk_fma_f32 v[110:111], v[102:103], v[94:95], v[110:111]
    s_cbranch_scc1 K_EV2
K_RET2:
    ds_read_b32 v144, v150 offset:24
    ds_read_b32 v146, v150 offset:28
    ds_read_b64 v[128:129], v151 offset:48
    ds_read_b64 v[132:133], v151 offset:56
    v_pk_add_f32 v[76:77], v[76:77], s[10:11] clamp
    v_pk_add_f32 v[80:81], v[80:81], s[10:11] clamp
    v_exp_f32 v68, v68
    v_pk_mul_f32 v[92:93], v[76:77], v[80:81]
    v_exp_f32 v69, v69
    v_pk_add_f32 v[78:79], v[78:79], s[10:11] clamp
    v_pk_add_f32 v[82:83], v[82:83], s[10:11] clamp
    v_exp_f32 v70, v70
    v_pk_mul_f32 v[94:95], v[78:79], v[82:83]
    v_exp_f32 v71, v71
    v_lshlrev_b64 v[84:85], 16, v[48:49]
    v_exp_f32 v72, v72
    v_lshlrev_b64 v[86:87], 16, v[54:55]
    v_exp_f32 v73, v73
    v_pk_add_f32 v[96:97], v[76:77], v[80:81]
    v_pk_add_f32 v[98:99], v[78:79], v[82:83]
    v_pk_mul_f32 v[100:101], v[80:81], v[84:85]
    v_pk_mul_f32 v[102:103], v[82:83], v[48:49]
    v_pk_fma_f32 v[100:101], v[76:77], v[86:87], v[100:101]
    v_pk_fma_f32 v[102:103], v[78:79], v[54:55], v[102:103]
    s_waitcnt vmcnt(4) lgkmcnt(0)
    buffer_load_dwordx4 v[46:49], v[144:145], s[24:27], 0 idxen offen sc1
    buffer_load_dwordx4 v[52:55], v[146:147], s[24:27], 0 idxen offen sc1
    s_sub_u32 s9, s9, 1
    v_mfma_f32_16x16x32_bf16 v[76:79], v[128:131], v[8:11], v[136:139]
    v_rcp_f32 v92, v92
    v_rcp_f32 v93, v93
    v_mfma_f32_16x16x32_bf16 v[80:83], v[132:135], v[14:17], v[136:139]
    v_rcp_f32 v94, v94
    v_rcp_f32 v95, v95
    v_exp_f32 v74, v74
    v_pk_fma_f32 v[104:105], v[96:97], v[92:93], v[104:105]
    v_exp_f32 v75, v75
    v_pk_fma_f32 v[106:107], v[98:99], v[94:95], v[106:107]
    v_pk_fma_f32 v[108:109], v[100:101], v[92:93], v[108:109]
    v_pk_fma_f32 v[110:111], v[102:103], v[94:95], v[110:111]
    s_cbranch_scc1 K_EV3
K_RET3:
    ds_read_b32 v144, v150 offset:32
    ds_read_b32 v146, v150 offset:36
    ds_read_b64 v[128:129], v151 offset:64
    ds_read_b64 v[132:133], v151 offset:72
    v_pk_add_f32 v[68:69], v[68:69], s[10:11] clamp
    v_pk_add_f32 v[72:73], v[72:73], s[10:11] clamp
    v_exp_f32 v76, v76
    v_pk_mul_f32 v[92:93], v[68:69], v[72:73]
    v_exp_f32 v77, v77
    v_pk_add_f32 v[70:71], v[70:71], s[10:11] clamp
    v_pk_add_f32 v[74:75], v[74:75], s[10:11] clamp
    v_exp_f32 v78, v78
    v_pk_mul_f32 v[94:95], v[70:71], v[74:75]
    v_exp_f32 v79, v79
    v_lshlrev_b64 v[84:85], 16, v[60:61]
    v_exp_f32 v80, v80
    v_lshlrev_b64 v[86:87], 16, v[66:67]
    v_exp_f32 v81, v81
    v_pk_add_f32 v[96:97], v[68:69], v[72:73]
    v_pk_add_f32 v[98:99], v[70:71], v[74:75]
    v_pk_mul_f32 v[100:101], v[72:73], v[84:85]
    v_pk_mul_f32 v[102:103], v[74:75], v[60:61]
    v_pk_fma_f32 v[100:101], v[68:69], v[86:87], v[100:101]
    v_pk_fma_f32 v[102:103], v[70:71], v[66:67], v[102:103]
    s_waitcnt vmcnt(4) lgkmcnt(0)
    buffer_load_dwordx4 v[58:61], v[144:145], s[24:27], 0 idxen offen sc1
    buffer_load_dwordx4 v[64:67], v[146:147], s[24:27], 0 idxen offen sc1
    s_sub_u32 s9, s9, 1
    v_mfma_f32_16x16x32_bf16 v[68:71], v[128:131], v[20:23], v[136:139]
    v_rcp_f32 v92, v92
    v_rcp_f32 v93, v93
    v_mfma_f32_16x16x32_bf16 v[72:75], v[132:135], v[26:29], v[136:139]
    v_rcp_f32 v94, v94
    v_rcp_f32 v95, v95
    v_exp_f32 v82, v82
    v_pk_fma_f32 v[104:105], v[96:97], v[92:93], v[104:105]
    v_exp_f32 v83, v83
    v_pk_fma_f32 v[106:107], v[98:99], v[94:95], v[106:107]
    v_pk_fma_f32 v[108:109], v[100:101], v[92:93], v[108:109]
    v_pk_fma_f32 v[110:111], v[102:103], v[94:95], v[110:111]
    s_cbranch_scc1 K_EV4
K_RET4:
    ds_read_b32 v144, v150 offset:40
    ds_read_b32 v146, v150 offset:44
    ds_read_b64 v[128:129], v151 offset:80
    ds_read_b64 v[132:133], v151 offset:88
    v_pk_add_f32 v[76:77], v[76:77], s[10:11] clamp
    v_pk_add_f32 v[80:81], v[80:81], s[10:11] clamp
    v_exp_f32 v68, v68
    v_pk_mul_f32 v[92:93], v[76:77], v[80:81]
    v_exp_f32 v69, v69
    v_pk_add_f32 v[78:79], v[78:79], s[10:11] clamp
    v_pk_add_f32 v[82:83], v[82:83], s[10:11] clamp
    v_exp_f32 v70, v70
    v_pk_mul_f32 v[94:95], v[78:79], v[82:83]
    v_exp_f32 v71, v71
    v_lshlrev_b64 v[84:85], 16, v[12:13]
    v_exp_f32 v72, v72
    v_lshlrev_b64 v[86:87], 16, v[18:19]
    v_exp_f32 v73, v73
    v_pk_add_f32 v[96:97], v[76:77], v[80:81]
    v_pk_add_f32 v[98:99], v[78:79], v[82:83]
    v_pk_mul_f32 v[100:101], v[80:81], v[84:85]
    v_pk_mul_f32 v[102:103], v[82:83], v[12:13]
    v_pk_fma_f32 v[100:101], v[76:77], v[86:87], v[100:101]
    v_pk_fma_f32 v[102:103], v[78:79], v[18:19], v[102:103]
    s_waitcnt vmcnt(4) lgkmcnt(0)
    buffer_load_dwordx4 v[10:13], v[144:145], s[24:27], 0 idxen offen sc1
    buffer_load_dwordx4 v[16:19], v[146:147], s[24:27], 0 idxen offen sc1
    s_sub_u32 s9, s9, 1
    v_mfma_f32_16x16x32_bf16 v[76:79], v[128:131], v[32:35], v[136:139]
    v_rcp_f32 v92, v92
    v_rcp_f32 v93, v93
    v_mfma_f32_16x16x32_bf16 v[80:83], v[132:135], v[38:41], v[136:139]
    v_rcp_f32 v94, v94
    v_rcp_f32 v95, v95
    v_exp_f32 v74, v74
    v_pk_fma_f32 v[104:105], v[96:97], v[92:93], v[104:105]
    v_exp_f32 v75, v75
    v_pk_fma_f32 v[106:107], v[98:99], v[94:95], v[106:107]
    v_pk_fma_f32 v[108:109], v[100:101], v[92:93], v[108:109]
    v_pk_fma_f32 v[110:111], v[102:103], v[94:95], v[110:111]
    s_cbranch_scc1 K_EV5
K_RET5:
    ds_read_b32 v144, v150 offset:48
    ds_read_b32 v146, v150 offset:52
    ds_read_b64 v[128:129], v151 offset:96
    ds_read_b64 v[132:133], v151 offset:104
    v_pk_add_f32 v[68:69], v[68:69], s[10:11] clamp
    v_pk_add_f32 v[72:73], v[72:73], s[10:11] clamp
    v_exp_f32 v76, v76
    v_pk_mul_f32 v[92:93], v[68:69], v[72:73]
    v_exp_f32 v77, v77
    v_pk_add_f32 v[70:71], v[70:71], s[10:11] clamp
    v_pk_add_f32 v[74:75], v[74:75], s[10:11] clamp
    v_exp_f32 v78, v78
    v_pk_mul_f32 v[94:95], v[70:71], v[74:75]
    v_exp_f32 v79, v79
    v_lshlrev_b64 v[84:85], 16, v[24:25]
    v_exp_f32 v80, v80
    v_lshlrev_b64 v[86:87], 16, v[30:31]
    v_exp_f32 v81, v81
    v_pk_add_f32 v[96:97], v[68:69], v[72:73]
    v_pk_add_f32 v[98:99], v[70:71], v[74:75]
    v_pk_mul_f32 v[100:101], v[72:73], v[84:85]
    v_pk_mul_f32 v[102:103], v[74:75], v[24:25]
    v_pk_fma_f32 v[100:101], v[68:69], v[86:87], v[100:101]
    v_pk_fma_f32 v[102:103], v[70:71], v[30:31], v[102:103]
    s_waitcnt vmcnt(4) lgkmcnt(0)
    buffer_load_dwordx4 v[22:25], v[144:145], s[24:27], 0 idxen offen sc1
    buffer_load_dwordx4 v[28:31], v[146:147], s[24:27], 0 idxen offen sc1
    s_sub_u32 s9, s9, 1
    v_mfma_f32_16x16x32_bf16 v[68:71], v[128:131], v[44:47], v[136:139]
    v_rcp_f32 v92, v92
    v_rcp_f32 v93, v93
    v_mfma_f32_16x16x32_bf16 v[72:75], v[132:135], v[50:53], v[136:139]
    v_rcp_f32 v94, v94
    v_rcp_f32 v95, v95
    v_exp_f32 v82, v82
    v_pk_fma_f32 v[104:105], v[96:97], v[92:93], v[104:105]
    v_exp_f32 v83, v83
    v_pk_fma_f32 v[106:107], v[98:99], v[94:95], v[106:107]
    v_pk_fma_f32 v[108:109], v[100:101], v[92:93], v[108:109]
    v_pk_fma_f32 v[110:111], v[102:103], v[94:95], v[110:111]
    s_cbranch_scc1 K_EV6
K_RET6:
    ds_read_b32 v144, v150 offset:56
    ds_read_b32 v146, v150 offset:60
    ds_read_b64 v[128:129], v151 offset:112
    ds_read_b64 v[132:133], v151 offset:120
    v_pk_add_f32 v[76:77], v[76:77], s[10:11] clamp
    v_pk_add_f32 v[80:81], v[80:81], s[10:11] clamp
    v_exp_f32 v68, v68
    v_pk_mul_f32 v[92:93], v[76:77], v[80:81]
    v_exp_f32 v69, v69
    v_pk_add_f32 v[78:79], v[78:79], s[10:11] clamp
    v_pk_add_f32 v[82:83], v[82:83], s[10:11] clamp
    v_exp_f32 v70, v70
    v_pk_mul_f32 v[94:95], v[78:79], v[82:83]
    v_exp_f32 v71, v71
    v_lshlrev_b64 v[84:85], 16, v[36:37]
    v_exp_f32 v72, v72
    v_lshlrev_b64 v[86:87], 16, v[42:43]
    v_exp_f32 v73, v73
    v_pk_add_f32 v[96:97], v[76:77], v[80:81]
    v_pk_add_f32 v[98:99], v[78:79], v[82:83]
    v_pk_mul_f32 v[100:101], v[80:81], v[84:85]
    v_pk_mul_f32 v[102:103], v[82:83], v[36:37]
    v_pk_fma_f32 v[100:101], v[76:77], v[86:87], v[100:101]
    v_pk_fma_f32 v[102:103], v[78:79], v[42:43], v[102:103]
    s_waitcnt vmcnt(4) lgkmcnt(0)
    buffer_load_dwordx4 v[34:37], v[144:145], s[24:27], 0 idxen offen sc1
    buffer_load_dwordx4 v[40:43], v[146:147], s[24:27], 0 idxen offen sc1
    s_sub_u32 s9, s9, 1
    v_mfma_f32_16x16x32_bf16 v[76:79], v[128:131], v[56:59], v[136:139]
    v_rcp_f32 v92, v92
    v_rcp_f32 v93, v93
    v_mfma_f32_16x16x32_bf16 v[80:83], v[132:135], v[62:65], v[136:139]
    v_rcp_f32 v94, v94
    v_rcp_f32 v95, v95
    v_exp_f32 v74, v74
    v_pk_fma_f32 v[104:105], v[96:97], v[92:93], v[104:105]
    v_exp_f32 v75, v75
    v_pk_fma_f32 v[106:107], v[98:99], v[94:95], v[106:107]
    v_pk_fma_f32 v[108:109], v[100:101], v[92:93], v[108:109]
    v_pk_fma_f32 v[110:111], v[102:103], v[94:95], v[110:111]
    s_cbranch_scc1 K_EV7
K_RET7:
    ds_read_b32 v144, v150 offset:64
    ds_read_b32 v146, v150 offset:68
    ds_read_b64 v[128:129], v151 offset:128
    ds_read_b64 v[132:133], v151 offset:136
    v_pk_add_f32 v[68:69], v[68:69], s[10:11] clamp
    v_pk_add_f32 v[72:73], v[72:73], s[10:11] clamp
    v_exp_f32 v76, v76
    v_pk_mul_f32 v[92:93], v[68:69], v[72:73]
    v_exp_f32 v77, v77
    v_pk_add_f32 v[70:71], v[70:71], s[10:11] clamp
    v_pk_add_f32 v[74:75], v[74:75], s[10:11] clamp
    v_exp_f32 v78, v78
    v_pk_mul_f32 v[94:95], v[70:71], v[74:75]
    v_exp_f32 v79, v79
    v_lshlrev_b64 v[84:85], 16, v[48:49]
    v_exp_f32 v80, v80
    v_lshlrev_b64 v[86:87], 16, v[54:55]
    v_exp_f32 v81, v81
    v_pk_add_f32 v[96:97], v[68:69], v[72:73]
    v_pk_add_f32 v[98:99], v[70:71], v[74:75]
    v_pk_mul_f32 v[100:101], v[72:73], v[84:85]
    v_pk_mul_f32 v[102:103], v[74:75], v[48:49]
    v_pk_fma_f32 v[100:101], v[68:69], v[86:87], v[100:101]
    v_pk_fma_f32 v[102:103], v[70:71], v[54:55], v[102:103]
    s_waitcnt vmcnt(4) lgkmcnt(0)
    buffer_load_dwordx4 v[46:49], v[144:145], s[24:27], 0 idxen offen sc1
    buffer_load_dwordx4 v[52:55], v[146:147], s[24:27], 0 idxen offen sc1
    s_sub_u32 s9, s9, 1
    v_mfma_f32_16x16x32_bf16 v[68:71], v[128:131], v[8:11], v[136:139]
    v_rcp_f32 v92, v92
    v_rcp_f32 v93, v93
    v_mfma_f32_16x16x32_bf16 v[72:75], v[132:135], v[14:17], v[136:139]
    v_rcp_f32 v94, v94
    v_rcp_f32 v95, v95
    v_exp_f32 v82, v82
    v_pk_fma_f32 v[104:105], v[96:97], v[92:93], v[104:105]
    v_exp_f32 v83, v83
    v_pk_fma_f32 v[106:107], v[98:99], v[94:95], v[106:107]
    v_pk_fma_f32 v[108:109], v[100:101], v[92:93], v[108:109]
    v_pk_fma_f32 v[110:111], v[102:103], v[94:95], v[110:111]
    s_cbranch_scc1 K_EV8
K_RET8:
    ds_read_b32 v144, v150 offset:72
    ds_read_b32 v146, v150 offset:76
    ds_read_b64 v[128:129], v151 offset:144
    ds_read_b64 v[132:133], v151 offset:152
    v_pk_add_f32 v[76:77], v[76:77], s[10:11] clamp
    v_pk_add_f32 v[80:81], v[80:81], s[10:11] clamp
    v_exp_f32 v68, v68
    v_pk_mul_f32 v[92:93], v[76:77], v[80:81]
    v_exp_f32 v69, v69
    v_pk_add_f32 v[78:79], v[78:79], s[10:11] clamp
    v_pk_add_f32 v[82:83], v[82:83], s[10:11] clamp
    v_exp_f32 v70, v70
    v_pk_mul_f32 v[94:95], v[78:79], v[82:83]
    v_exp_f32 v71, v71
    v_lshlrev_b64 v[84:85], 16, v[60:61]
    v_exp_f32 v72, v72
    v_lshlrev_b64 v[86:87], 16, v[66:67]
    v_exp_f32 v73, v73
    v_add_u32 v150, 80, v150
    v_add_u32 v151, v157, v151
    v_pk_add_f32 v[96:97], v[76:77], v[80:81]
    v_pk_add_f32 v[98:99], v[78:79], v[82:83]
    v_pk_mul_f32 v[100:101], v[80:81], v[84:85]
    v_pk_mul_f32 v[102:103], v[82:83], v[60:61]
    v_pk_fma_f32 v[100:101], v[76:77], v[86:87], v[100:101]
    v_pk_fma_f32 v[102:103], v[78:79], v[66:67], v[102:103]
    s_waitcnt vmcnt(4) lgkmcnt(0)
    buffer_load_dwordx4 v[58:61], v[144:145], s[24:27], 0 idxen offen sc1
    buffer_load_dwordx4 v[64:67], v[146:147], s[24:27], 0 idxen offen sc1
    s_sub_u32 s9, s9, 1
    v_mfma_f32_16x16x32_bf16 v[76:79], v[128:131], v[20:23], v[136:139]
    v_rcp_f32 v92, v92
    v_rcp_f32 v93, v93
    v_mfma_f32_16x16x32_bf16 v[80:83], v[132:135], v[26:29], v[136:139]
    v_rcp_f32 v94, v94
    v_rcp_f32 v95, v95
    v_exp_f32 v74, v74
    v_pk_fma_f32 v[104:105], v[96:97], v[92:93], v[104:105]
    v_exp_f32 v75, v75
    v_pk_fma_f32 v[106:107], v[98:99], v[94:95], v[106:107]
    v_pk_fma_f32 v[108:109], v[100:101], v[92:93], v[108:109]
    v_pk_fma_f32 v[110:111], v[102:103], v[94:95], v[110:111]
    s_cbranch_scc0 K_LOOP
K_EV9:
    s_ff1_i32_b64 s14, s[56:57]
    s_bitset0_b64 s[56:57], s14
    s_ff1_i32_b64 s9, s[56:57]
    s_lshr_b64 s[40:41], s[60:61], s14
    s_sub_u32 s9, s9, s14
    s_sub_u32 s9, s9, 1
    s_bitcmp1_b32 s40, 1
    s_cbranch_scc0 K_EV9A
    ds_write_b128 v152, v[104:107]
    ds_write_b128 v152, v[108:111] offset:256
    s_lshr_b64 s[42:43], s[40:41], 2
    s_cbranch_scc0 K_LOOP_DONE
    v_mov_b32 v152, v153
    v_add_u32 v153, 2048, v153
    v_pk_mov_b32 v[104:105], 0, 0
    v_pk_mov_b32 v[106:107], 0, 0
    v_pk_mov_b32 v[108:109], 0, 0
    v_pk_mov_b32 v[110:111], 0, 0
K_EV9A:
    s_bitcmp1_b32 s40, 3
    s_cbranch_scc0 K_EV9B
    v_lshlrev_b32 v151, 1, v156
    v_add_u32 v151, 2048, v151
    v_mov_b32 v4, 384
    v_pk_mov_b32 v[136:137], v[140:141], v[140:141] op_sel:[0,1]
    v_pk_mov_b32 v[138:139], v[142:143], v[142:143] op_sel:[0,1]
    v_cndmask_b32_e64 v151, v4, v151, s[62:63]
K_EV9B:
    s_bitcmp1_b32 s40, 6
    s_cbranch_scc0 K_EV9C
    v_mov_b32 v150, 1280
    s_lshr_b64 s[42:43], s[40:41], 7
    s_cbranch_scc0 K_EV9C
    v_add_u32 v150, 53824, v148
    v_add_u32 v4, v149, v145
    v_add_u32 v154, 32, v154
    v_add_u32 v155, 32, v155
    ds_read_b128 v[140:143], v4
    ds_read_b32 v156, v155 offset:640
    ds_read_b64 v[148:149], v154 offset:672
K_EV9C:
    s_bitcmp1_b64 s[54:55], s14
    s_cbranch_scc0 K_LOOP
    s_sub_u32 s58, s58, 1
    s_setprio 0
    s_cmp_eq_u32 s58, 0
    s_cbranch_scc1 K_LOOP
    s_setprio 1
    s_cmp_eq_u32 s58, 1
    s_cbranch_scc1 K_LOOP
    s_setprio 2
    s_branch K_LOOP
K_EV0:
    s_ff1_i32_b64 s14, s[56:57]
    s_bitset0_b64 s[56:57], s14
    s_ff1_i32_b64 s9, s[56:57]
    s_lshr_b64 s[40:41], s[60:61], s14
    s_sub_u32 s9, s9, s14
    s_sub_u32 s9, s9, 1
    s_bitcmp1_b32 s40, 1
    s_cbranch_scc0 K_EV0A
    ds_write_b128 v152, v[104:107]
    ds_write_b128 v152, v[108:111] offset:256
    s_lshr_b64 s[42:43], s[40:41], 2
    s_cbranch_scc0 K_LOOP_DONE
    v_mov_b32 v152, v153
    v_add_u32 v153, 2048, v153
    v_pk_mov_b32 v[104:105], 0, 0
    v_pk_mov_b32 v[106:107], 0, 0
    v_pk_mov_b32 v[108:109], 0, 0
    v_pk_mov_b32 v[110:111], 0, 0
K_EV0A:
    s_bitcmp1_b32 s40, 3
    s_cbranch_scc0 K_EV0B
    v_lshlrev_b32 v151, 1, v156
    v_add_u32 v151, 2032, v151
    v_mov_b32 v4, 384
    v_pk_mov_b32 v[136:137], v[140:141], v[140:141] op_sel:[0,1]
    v_pk_mov_b32 v[138:139], v[142:143], v[142:143] op_sel:[0,1]
    v_cndmask_b32_e64 v151, v4, v151, s[62:63]
K_EV0B:
    s_bitcmp1_b32 s40, 6
    s_cbranch_scc0 K_EV0C
    v_mov_b32 v150, 1272
    s_lshr_b64 s[42:43], s[40:41], 7
    s_cbranch_scc0 K_EV0C
    v_add_u32 v150, 53816, v148
    v_add_u32 v4, v149, v145
    v_add_u32 v154, 32, v154
    v_add_u32 v155, 32, v155
    ds_read_b128 v[140:143], v4
    ds_read_b32 v156, v155 offset:640
    ds_read_b64 v[148:149], v154 offset:672
K_EV0C:
    s_bitcmp1_b64 s[54:55], s14
    s_cbranch_scc0 K_RET0
    s_sub_u32 s58, s58, 1
    s_setprio 0
    s_cmp_eq_u32 s58, 0
    s_cbranch_scc1 K_RET0
    s_setprio 1
    s_cmp_eq_u32 s58, 1
    s_cbranch_scc1 K_RET0
    s_setprio 2
    s_branch K_RET0
K_EV1:
    s_ff1_i32_b64 s14, s[56:57]
    s_bitset0_b64 s[56:57], s14
    s_ff1_i32_b64 s9, s[56:57]
    s_lshr_b64 s[40:41], s[60:61], s14
    s_sub_u32 s9, s9, s14
    s_sub_u32 s9, s9, 1
    s_bitcmp1_b32 s40, 1
    s_cbranch_scc0 K_EV1A
    ds_write_b128 v152, v[104:107]
    ds_write_b128 v152, v[108:111] offset:256
    s_lshr_b64 s[42:43], s[40:41], 2
    s_cbranch_scc0 K_LOOP_DONE
    v_mov_b32 v152, v153
    v_add_u32 v153, 2048, v153
    v_pk_mov_b32 v[104:105], 0, 0
    v_pk_mov_b32 v[106:107], 0, 0
    v_pk_mov_b32 v[108:109], 0, 0
    v_pk_mov_b32 v[110:111], 0, 0
K_EV1A:
    s_bitcmp1_b32 s40, 3
    s_cbranch_scc0 K_EV1B
    v_lshlrev_b32 v151, 1, v156
    v_add_u32 v151, 2016, v151
    v_mov_b32 v4, 384
    v_pk_mov_b32 v[136:137], v[140:141], v[140:141] op_sel:[0,1]
    v_pk_mov_b32 v[138:139], v[142:143], v[142:143] op_sel:[0,1]
    v_cndmask_b32_e64 v151, v4, v151, s[62:63]
K_EV1B:
    s_bitcmp1_b32 s40, 6
    s_cbranch_scc0 K_EV1C
    v_mov_b32 v150, 1264
    s_lshr_b64 s[42:43], s[40:41], 7
    s_cbranch_scc0 K_EV1C
    v_add_u32 v150, 53808, v148
    v_add_u32 v4, v149, v145
    v_add_u32 v154, 32, v154
    v_add_u32 v155, 32, v155
    ds_read_b128 v[140:143], v4
    ds_read_b32 v156, v155 offset:640
    ds_read_b64 v[148:149], v154 offset:672
K_EV1C:
    s_bitcmp1_b64 s[54:55], s14
    s_cbranch_scc0 K_RET1
    s_sub_u32 s58, s58, 1
    s_setprio 0
    s_cmp_eq_u32 s58, 0
    s_cbranch_scc1 K_RET1
    s_setprio 1
    s_cmp_eq_u32 s58, 1
    s_cbranch_scc1 K_RET1
    s_setprio 2
    s_branch K_RET1
K_EV2:
    s_ff1_i32_b64 s14, s[56:57]
    s_bitset0_b64 s[56:57], s14
    s_ff1_i32_b64 s9, s[56:57]
    s_lshr_b64 s[40:41], s[60:61], s14
    s_sub_u32 s9, s9, s14
    s_sub_u32 s9, s9, 1
    s_bitcmp1_b32 s40, 1
    s_cbranch_scc0 K_EV2A
    ds_write_b128 v152, v[104:107]
    ds_write_b128 v152, v[108:111] offset:256
    s_lshr_b64 s[42:43], s[40:41], 2
    s_cbranch_scc0 K_LOOP_DONE
    v_mov_b32 v152, v153
    v_add_u32 v153, 2048, v153
    v_pk_mov_b32 v[104:105], 0, 0
    v_pk_mov_b32 v[106:107], 0, 0
    v_pk_mov_b32 v[108:109], 0, 0
    v_pk_mov_b32 v[110:111], 0, 0
K_EV2A:
    s_bitcmp1_b32 s40, 3
    s_cbranch_scc0 K_EV2B
    v_lshlrev_b32 v151, 1, v156
    v_add_u32 v151, 2000, v151
    v_mov_b32 v4, 384
    v_pk_mov_b32 v[136:137], v[140:141], v[140:141] op_sel:[0,1]
    v_pk_mov_b32 v[138:139], v[142:143], v[142:143] op_sel:[0,1]
    v_cndmask_b32_e64 v151, v4, v151, s[62:63]
K_EV2B:
    s_bitcmp1_b32 s40, 6
    s_cbranch_scc0 K_EV2C
    v_mov_b32 v150, 1256
    s_lshr_b64 s[42:43], s[40:41], 7
    s_cbranch_scc0 K_EV2C
    v_add_u32 v150, 53800, v148
    v_add_u32 v4, v149, v145
    v_add_u32 v154, 32, v154
    v_add_u32 v155, 32, v155
    ds_read_b128 v[140:143], v4
    ds_read_b32 v156, v155 offset:640
    ds_read_b64 v[148:149], v154 offset:672
K_EV2C:
    s_bitcmp1_b64 s[54:55], s14
    s_cbranch_scc0 K_RET2
    s_sub_u32 s58, s58, 1
    s_setprio 0
    s_cmp_eq_u32 s58, 0
    s_cbranch_scc1 K_RET2
    s_setprio 1
    s_cmp_eq_u32 s58, 1
    s_cbranch_scc1 K_RET2
    s_setprio 2
    s_branch K_RET2
K_EV3:
    s_ff1_i32_b64 s14, s[56:57]
    s_bitset0_b64 s[56:57], s14
    s_ff1_i32_b64 s9, s[56:57]
    s_lshr_b64 s[40:41], s[60:61], s14
    s_sub_u32 s9, s9, s14
    s_sub_u32 s9, s9, 1
    s_bitcmp1_b32 s40, 1
    s_cbranch_scc0 K_EV3A
    ds_write_b128 v152, v[104:107]
    ds_write_b128 v152, v[108:111] offset:256
    s_lshr_b64 s[42:43], s[40:41], 2
    s_cbranch_scc0 K_LOOP_DONE
    v_mov_b32 v152, v153
    v_add_u32 v153, 2048, v153
    v_pk_mov_b32 v[104:105], 0, 0
    v_pk_mov_b32 v[106:107], 0, 0
    v_pk_mov_b32 v[108:109], 0, 0
    v_pk_mov_b32 v[110:111], 0, 0
K_EV3A:
    s_bitcmp1_b32 s40, 3
    s_cbranch_scc0 K_EV3B
    v_lshlrev_b32 v151, 1, v156
    v_add_u32 v151, 1984, v151
    v_mov_b32 v4, 384
    v_pk_mov_b32 v[136:137], v[140:141], v[140:141] op_sel:[0,1]
    v_pk_mov_b32 v[138:139], v[142:143], v[142:143] op_sel:[0,1]
    v_cndmask_b32_e64 v151, v4, v151, s[62:63]
K_EV3B:
    s_bitcmp1_b32 s40, 6
    s_cbranch_scc0 K_EV3C
    v_mov_b32 v150, 1248
    s_lshr_b64 s[42:43], s[40:41], 7
    s_cbranch_scc0 K_EV3C
    v_add_u32 v150, 53792, v148
    v_add_u32 v4, v149, v145
    v_add_u32 v154, 32, v154
    v_add_u32 v155, 32, v155
    ds_read_b128 v[140:143], v4
    ds_read_b32 v156, v155 offset:640
    ds_read_b64 v[148:149], v154 offset:672
K_EV3C:
    s_bitcmp1_b64 s[54:55], s14
    s_cbranch_scc0 K_RET3
    s_sub_u32 s58, s58, 1
    s_setprio 0
    s_cmp_eq_u32 s58, 0
    s_cbranch_scc1 K_RET3
    s_setprio 1
    s_cmp_eq_u32 s58, 1
    s_cbranch_scc1 K_RET3
    s_setprio 2
    s_branch K_RET3
K_EV4:
    s_ff1_i32_b64 s14, s[56:57]
    s_bitset0_b64 s[56:57], s14
    s_ff1_i32_b64 s9, s[56:57]
    s_lshr_b64 s[40:41], s[60:61], s14
    s_sub_u32 s9, s9, s14
    s_sub_u32 s9, s9, 1
    s_bitcmp1_b32 s40, 1
    s_cbranch_scc0 K_EV4A
    ds_write_b128 v152, v[104:107]
    ds_write_b128 v152, v[108:111] offset:256
    s_lshr_b64 s[42:43], s[40:41], 2
    s_cbranch_scc0 K_LOOP_DONE
    v_mov_b32 v152, v153
    v_add_u32 v153, 2048, v153
    v_pk_mov_b32 v[104:105], 0, 0
    v_pk_mov_b32 v[106:107], 0, 0
    v_pk_mov_b32 v[108:109], 0, 0
    v_pk_mov_b32 v[110:111], 0, 0
K_EV4A:
    s_bitcmp1_b32 s40, 3
    s_cbranch_scc0 K_EV4B
    v_lshlrev_b32 v151, 1, v156
    v_add_u32 v151, 1968, v151
    v_mov_b32 v4, 384
    v_pk_mov_b32 v[136:137], v[140:141], v[140:141] op_sel:[0,1]
    v_pk_mov_b32 v[138:139], v[142:143], v[142:143] op_sel:[0,1]
    v_cndmask_b32_e64 v151, v4, v151, s[62:63]
K_EV4B:
    s_bitcmp1_b32 s40, 6
    s_cbranch_scc0 K_EV4C
    v_mov_b32 v150, 1240
    s_lshr_b64 s[42:43], s[40:41], 7
    s_cbranch_scc0 K_EV4C
    v_add_u32 v150, 53784, v148
    v_add_u32 v4, v149, v145
    v_add_u32 v154, 32, v154
    v_add_u32 v155, 32, v155
    ds_read_b128 v[140:143], v4
    ds_read_b32 v156, v155 offset:640
    ds_read_b64 v[148:149], v154 offset:672
K_EV4C:
    s_bitcmp1_b64 s[54:55], s14
    s_cbranch_scc0 K_RET4
    s_sub_u32 s58, s58, 1
    s_setprio 0
    s_cmp_eq_u32 s58, 0
    s_cbranch_scc1 K_RET4
    s_setprio 1
    s_cmp_eq_u32 s58, 1
    s_cbranch_scc1 K_RET4
    s_setprio 2
    s_branch K_RET4
K_EV5:
    s_ff1_i32_b64 s14, s[56:57]
    s_bitset0_b64 s[56:57], s14
    s_ff1_i32_b64 s9, s[56:57]
    s_lshr_b64 s[40:41], s[60:61], s14
    s_sub_u32 s9, s9, s14
    s_sub_u32 s9, s9, 1
    s_bitcmp1_b32 s40, 1
    s_cbranch_scc0 K_EV5A
    ds_write_b128 v152, v[104:107]
    ds_write_b128 v152, v[108:111] offset:256
    s_lshr_b64 s[42:43], s[40:41], 2
    s_cbranch_scc0 K_LOOP_DONE
    v_mov_b32 v152, v153
    v_add_u32 v153, 2048, v153
    v_pk_mov_b32 v[104:105], 0, 0
    v_pk_mov_b32 v[106:107], 0, 0
    v_pk_mov_b32 v[108:109], 0, 0
    v_pk_mov_b32 v[110:111], 0, 0
K_EV5A:
    s_bitcmp1_b32 s40, 3
    s_cbranch_scc0 K_EV5B
    v_lshlrev_b32 v151, 1, v156
    v_add_u32 v151, 1952, v151
    v_mov_b32 v4, 384
    v_pk_mov_b32 v[136:137], v[140:141], v[140:141] op_sel:[0,1]
    v_pk_mov_b32 v[138:139], v[142:143], v[142:143] op_sel:[0,1]
    v_cndmask_b32_e64 v151, v4, v151, s[62:63]
K_EV5B:
    s_bitcmp1_b32 s40, 6
    s_cbranch_scc0 K_EV5C
    v_mov_b32 v150, 1232
    s_lshr_b64 s[42:43], s[40:41], 7
    s_cbranch_scc0 K_EV5C
    v_add_u32 v150, 53776, v148
    v_add_u32 v4, v149, v145
    v_add_u32 v154, 32, v154
    v_add_u32 v155, 32, v155
    ds_read_b128 v[140:143], v4
    ds_read_b32 v156, v155 offset:640
    ds_read_b64 v[148:149], v154 offset:672
K_EV5C:
    s_bitcmp1_b64 s[54:55], s14
    s_cbranch_scc0 K_RET5
    s_sub_u32 s58, s58, 1
    s_setprio 0
    s_cmp_eq_u32 s58, 0
    s_cbranch_scc1 K_RET5
    s_setprio 1
    s_cmp_eq_u32 s58, 1
    s_cbranch_scc1 K_RET5
    s_setprio 2
    s_branch K_RET5
K_EV6:
    s_ff1_i32_b64 s14, s[56:57]
    s_bitset0_b64 s[56:57], s14
    s_ff1_i32_b64 s9, s[56:57]
    s_lshr_b64 s[40:41], s[60:61], s14
    s_sub_u32 s9, s9, s14
    s_sub_u32 s9, s9, 1
    s_bitcmp1_b32 s40, 1
    s_cbranch_scc0 K_EV6A
    ds_write_b128 v152, v[104:107]
    ds_write_b128 v152, v[108:111] offset:256
    s_lshr_b64 s[42:43], s[40:41], 2
    s_cbranch_scc0 K_LOOP_DONE
    v_mov_b32 v152, v153
    v_add_u32 v153, 2048, v153
    v_pk_mov_b32 v[104:105], 0, 0
    v_pk_mov_b32 v[106:107], 0, 0
    v_pk_mov_b32 v[108:109], 0, 0
    v_pk_mov_b32 v[110:111], 0, 0
K_EV6A:
    s_bitcmp1_b32 s40, 3
    s_cbranch_scc0 K_EV6B
    v_lshlrev_b32 v151, 1, v156
    v_add_u32 v151, 1936, v151
    v_mov_b32 v4, 384
    v_pk_mov_b32 v[136:137], v[140:141], v[140:141] op_sel:[0,1]
    v_pk_mov_b32 v[138:139], v[142:143], v[142:143] op_sel:[0,1]
    v_cndmask_b32_e64 v151, v4, v151, s[62:63]
K_EV6B:
    s_bitcmp1_b32 s40, 6
    s_cbranch_scc0 K_EV6C
    v_mov_b32 v150, 1224
    s_lshr_b64 s[42:43], s[40:41], 7
    s_cbranch_scc0 K_EV6C
    v_add_u32 v150, 53768, v148
    v_add_u32 v4, v149, v145
    v_add_u32 v154, 32, v154
    v_add_u32 v155, 32, v155
    ds_read_b128 v[140:143], v4
    ds_read_b32 v156, v155 offset:640
    ds_read_b64 v[148:149], v154 offset:672
K_EV6C:
    s_bitcmp1_b64 s[54:55], s14
    s_cbranch_scc0 K_RET6
    s_sub_u32 s58, s58, 1
    s_setprio 0
    s_cmp_eq_u32 s58, 0
    s_cbranch_scc1 K_RET6
    s_setprio 1
    s_cmp_eq_u32 s58, 1
    s_cbranch_scc1 K_RET6
    s_setprio 2
    s_branch K_RET6
K_EV7:
    s_ff1_i32_b64 s14, s[56:57]
    s_bitset0_b64 s[56:57], s14
    s_ff1_i32_b64 s9, s[56:57]
    s_lshr_b64 s[40:41], s[60:61], s14
    s_sub_u32 s9, s9, s14
    s_sub_u32 s9, s9, 1
    s_bitcmp1_b32 s40, 1
    s_cbranch_scc0 K_EV7A
    ds_write_b128 v152, v[104:107]
    ds_write_b128 v152, v[108:111] offset:256
    s_lshr_b64 s[42:43], s[40:41], 2
    s_cbranch_scc0 K_LOOP_DONE
    v_mov_b32 v152, v153
    v_add_u32 v153, 2048, v153
    v_pk_mov_b32 v[104:105], 0, 0
    v_pk_mov_b32 v[106:107], 0, 0
    v_pk_mov_b32 v[108:109], 0, 0
    v_pk_mov_b32 v[110:111], 0, 0
K_EV7A:
    s_bitcmp1_b32 s40, 3
    s_cbranch_scc0 K_EV7B
    v_lshlrev_b32 v151, 1, v156
    v_add_u32 v151, 1920, v151
    v_mov_b32 v4, 384
    v_pk_mov_b32 v[136:137], v[140:141], v[140:141] op_sel:[0,1]
    v_pk_mov_b32 v[138:139], v[142:143], v[142:143] op_sel:[0,1]
    v_cndmask_b32_e64 v151, v4, v151, s[62:63]
K_EV7B:
    s_bitcmp1_b32 s40, 6
    s_cbranch_scc0 K_EV7C
    v_mov_b32 v150, 1216
    s_lshr_b64 s[42:43], s[40:41], 7
    s_cbranch_scc0 K_EV7C
    v_add_u32 v150, 53760, v148
    v_add_u32 v4, v149, v145
    v_add_u32 v154, 32, v154
    v_add_u32 v155, 32, v155
    ds_read_b128 v[140:143], v4
    ds_read_b32 v156, v155 offset:640
    ds_read_b64 v[148:149], v154 offset:672
K_EV7C:
    s_bitcmp1_b64 s[54:55], s14
    s_cbranch_scc0 K_RET7
    s_sub_u32 s58, s58, 1
    s_setprio 0
    s_cmp_eq_u32 s58, 0
    s_cbranch_scc1 K_RET7
    s_setprio 1
    s_cmp_eq_u32 s58, 1
    s_cbranch_scc1 K_RET7
    s_setprio 2
    s_branch K_RET7
K_EV8:
    s_ff1_i32_b64 s14, s[56:57]
    s_bitset0_b64 s[56:57], s14
    s_ff1_i32_b64 s9, s[56:57]
    s_lshr_b64 s[40:41], s[60:61], s14
    s_sub_u32 s9, s9, s14
    s_sub_u32 s9, s9, 1
    s_bitcmp1_b32 s40, 1
    s_cbranch_scc0 K_EV8A
    ds_write_b128 v152, v[104:107]
    ds_write_b128 v152, v[108:111] offset:256
    s_lshr_b64 s[42:43], s[40:41], 2
    s_cbranch_scc0 K_LOOP_DONE
    v_mov_b32 v152, v153
    v_add_u32 v153, 2048, v153
    v_pk_mov_b32 v[104:105], 0, 0
    v_pk_mov_b32 v[106:107], 0, 0
    v_pk_mov_b32 v[108:109], 0, 0
    v_pk_mov_b32 v[110:111], 0, 0
K_EV8A:
    s_bitcmp1_b32 s40, 3
    s_cbranch_scc0 K_EV8B
    v_lshlrev_b32 v151, 1, v156
    v_add_u32 v151, 1904, v151
    v_mov_b32 v4, 384
    v_pk_mov_b32 v[136:137], v[140:141], v[140:141] op_sel:[0,1]
    v_pk_mov_b32 v[138:139], v[142:143], v[142:143] op_sel:[0,1]
    v_cndmask_b32_e64 v151, v4, v151, s[62:63]
K_EV8B:
    s_bitcmp1_b32 s40, 6
    s_cbranch_scc0 K_EV8C
    v_mov_b32 v150, 1208
    s_lshr_b64 s[42:43], s[40:41], 7
    s_cbranch_scc0 K_EV8C
    v_add_u32 v150, 53752, v148
    v_add_u32 v4, v149, v145
    v_add_u32 v154, 32, v154
    v_add_u32 v155, 32, v155
    ds_read_b128 v[140:143], v4
    ds_read_b32 v156, v155 offset:640
    ds_read_b64 v[148:149], v154 offset:672
K_EV8C:
    s_bitcmp1_b64 s[54:55], s14
    s_cbranch_scc0 K_RET8
    s_sub_u32 s58, s58, 1
    s_setprio 0
    s_cmp_eq_u32 s58, 0
    s_cbranch_scc1 K_RET8
    s_setprio 1
    s_cmp_eq_u32 s58, 1
    s_cbranch_scc1 K_RET8
    s_setprio 2
    s_branch K_RET8
K_LOOP_DONE:
    s_setprio 0
    s_waitcnt lgkmcnt(0)
    s_barrier
    s_mov_b64 exec, s[20:21]
    s_cbranch_execz K_COMB_DONE
    ds_read_b32 v68, v236 offset:256
    ds_read_b128 v[72:75], v234
    ds_read_b128 v[76:79], v234 offset:16
    ds_read_b128 v[80:83], v234 offset:256
    ds_read_b128 v[84:87], v234 offset:272
    s_waitcnt lgkmcnt(4)
K_COMB_A:
    v_ffbl_b32 v69, v68
    v_cmp_ne_u32 vcc, 0, v68
    v_add_u32 v70, -1, v68
    v_and_b32 v68, v68, v70
    v_lshl_add_u32 v69, v69, 11, v235
    s_mov_b64 s[40:41], exec
    s_and_b64 exec, exec, vcc
    s_cbranch_execz K_COMB_LA
    ds_read_b128 v[88:91], v69
    ds_read_b128 v[92:95], v69 offset:16
    ds_read_b128 v[96:99], v69 offset:256
    ds_read_b128 v[100:103], v69 offset:272
    s_mov_b64 s[42:43], exec
    s_mov_b64 exec, s[40:41]
    s_waitcnt lgkmcnt(4)
    v_pk_add_f32 v[158:159], v[158:159], v[72:73]
    v_pk_add_f32 v[160:161], v[160:161], v[74:75]
    v_pk_add_f32 v[162:163], v[162:163], v[76:77]
    v_pk_add_f32 v[164:165], v[164:165], v[78:79]
    v_pk_add_f32 v[166:167], v[166:167], v[80:81]
    v_pk_add_f32 v[168:169], v[168:169], v[82:83]
    v_pk_add_f32 v[170:171], v[170:171], v[84:85]
    v_pk_add_f32 v[172:173], v[172:173], v[86:87]
    s_mov_b64 exec, s[42:43]
    v_ffbl_b32 v69, v68
    v_cmp_ne_u32 vcc, 0, v68
    v_add_u32 v70, -1, v68
    v_and_b32 v68, v68, v70
    v_lshl_add_u32 v69, v69, 11, v235
    s_mov_b64 s[40:41], exec
    s_and_b64 exec, exec, vcc
    s_cbranch_execz K_COMB_LB
    ds_read_b128 v[72:75], v69
    ds_read_b128 v[76:79], v69 offset:16
    ds_read_b128 v[80:83], v69 offset:256
    ds_read_b128 v[84:87], v69 offset:272
    s_mov_b64 s[42:43], exec
    s_mov_b64 exec, s[40:41]
    s_waitcnt lgkmcnt(4)
    v_pk_add_f32 v[158:159], v[158:159], v[88:89]
    v_pk_add_f32 v[160:161], v[160:161], v[90:91]
    v_pk_add_f32 v[162:163], v[162:163], v[92:93]
    v_pk_add_f32 v[164:165], v[164:165], v[94:95]
    v_pk_add_f32 v[166:167], v[166:167], v[96:97]
    v_pk_add_f32 v[168:169], v[168:169], v[98:99]
    v_pk_add_f32 v[170:171], v[170:171], v[100:101]
    v_pk_add_f32 v[172:173], v[172:173], v[102:103]
    s_mov_b64 exec, s[42:43]
    s_branch K_COMB_A
K_COMB_LB:
    s_mov_b64 exec, s[40:41]
    s_waitcnt lgkmcnt(0)
    v_pk_add_f32 v[158:159], v[158:159], v[88:89]
    v_pk_add_f32 v[160:161], v[160:161], v[90:91]
    v_pk_add_f32 v[162:163], v[162:163], v[92:93]
    v_pk_add_f32 v[164:165], v[164:165], v[94:95]
    v_pk_add_f32 v[166:167], v[166:167], v[96:97]
    v_pk_add_f32 v[168:169], v[168:169], v[98:99]
    v_pk_add_f32 v[170:171], v[170:171], v[100:101]
    v_pk_add_f32 v[172:173], v[172:173], v[102:103]
    s_branch K_COMB_DONE
K_COMB_LA:
    s_mov_b64 exec, s[40:41]
    s_waitcnt lgkmcnt(0)
    v_pk_add_f32 v[158:159], v[158:159], v[72:73]
    v_pk_add_f32 v[160:161], v[160:161], v[74:75]
    v_pk_add_f32 v[162:163], v[162:163], v[76:77]
    v_pk_add_f32 v[164:165], v[164:165], v[78:79]
    v_pk_add_f32 v[166:167], v[166:167], v[80:81]
    v_pk_add_f32 v[168:169], v[168:169], v[82:83]
    v_pk_add_f32 v[170:171], v[170:171], v[84:85]
    v_pk_add_f32 v[172:173], v[172:173], v[86:87]
K_COMB_DONE:
    s_mov_b64 exec, -1
    s_cmp_lg_u32 s5, 0
    s_cbranch_scc1 K_SLOW_NEXT
K_FINAL:
    s_cmp_lg_u32 s3, 6
    s_cbranch_scc1 K_FIN2
    v_add_f32_dpp v158, v158, v158 row_ror:8 row_mask:0xf bank_mask:0xf
    v_add_f32_dpp v159, v159, v159 row_ror:8 row_mask:0xf bank_mask:0xf
    v_add_f32_dpp v160, v160, v160 row_ror:8 row_mask:0xf bank_mask:0xf
    v_add_f32_dpp v161, v161, v161 row_ror:8 row_mask:0xf bank_mask:0xf
    v_add_f32_dpp v162, v162, v162 row_ror:8 row_mask:0xf bank_mask:0xf
    v_add_f32_dpp v163, v163, v163 row_ror:8 row_mask:0xf bank_mask:0xf
    v_add_f32_dpp v164, v164, v164 row_ror:8 row_mask:0xf bank_mask:0xf
    v_add_f32_dpp v165, v165, v165 row_ror:8 row_mask:0xf bank_mask:0xf
    v_add_f32_dpp v166, v166, v166 row_ror:8 row_mask:0xf bank_mask:0xf
    v_add_f32_dpp v167, v167, v167 row_ror:8 row_mask:0xf bank_mask:0xf
    v_add_f32_dpp v168, v168, v168 row_ror:8 row_mask:0xf bank_mask:0xf
    v_add_f32_dpp v169, v169, v169 row_ror:8 row_mask:0xf bank_mask:0xf
    v_add_f32_dpp v170, v170, v170 row_ror:8 row_mask:0xf bank_mask:0xf
    v_add_f32_dpp v171, v171, v171 row_ror:8 row_mask:0xf bank_mask:0xf
    v_add_f32_dpp v172, v172, v172 row_ror:8 row_mask:0xf bank_mask:0xf
    v_add_f32_dpp v173, v173, v173 row_ror:8 row_mask:0xf bank_mask:0xf
    ds_swizzle_b32 v72, v158 offset:0x401F
    ds_swizzle_b32 v73, v159 offset:0x401F
    ds_swizzle_b32 v74, v160 offset:0x401F
    ds_swizzle_b32 v75, v161 offset:0x401F
    ds_swizzle_b32 v76, v162 offset:0x401F
    ds_swizzle_b32 v77, v163 offset:0x401F
    ds_swizzle_b32 v78, v164 offset:0x401F
    ds_swizzle_b32 v79, v165 offset:0x401F
    ds_swizzle_b32 v80, v166 offset:0x401F
    ds_swizzle_b32 v81, v167 offset:0x401F
    ds_swizzle_b32 v82, v168 offset:0x401F
    ds_swizzle_b32 v83, v169 offset:0x401F
    ds_swizzle_b32 v84, v170 offset:0x401F
    ds_swizzle_b32 v85, v171 offset:0x401F
    ds_swizzle_b32 v86, v172 offset:0x401F
    ds_swizzle_b32 v87, v173 offset:0x401F
    s_waitcnt lgkmcnt(0)
    v_pk_add_f32 v[158:159], v[158:159], v[72:73]
    v_pk_add_f32 v[160:161], v[160:161], v[74:75]
    v_pk_add_f32 v[162:163], v[162:163], v[76:77]
    v_pk_add_f32 v[164:165], v[164:165], v[78:79]
    v_pk_add_f32 v[166:167], v[166:167], v[80:81]
    v_pk_add_f32 v[168:169], v[168:169], v[82:83]
    v_pk_add_f32 v[170:171], v[170:171], v[84:85]
    v_pk_add_f32 v[172:173], v[172:173], v[86:87]
K_FIN2:
    s_mov_b32 s14, 0x538637bd
    s_mov_b32 s15, 0x538637bd
    v_pk_add_f32 v[158:159], v[158:159], s[14:15]
    v_pk_add_f32 v[160:161], v[160:161], s[14:15]
    v_pk_add_f32 v[162:163], v[162:163], s[14:15]
    v_pk_add_f32 v[164:165], v[164:165], s[14:15]
    v_rcp_f32 v158, v158
    v_rcp_f32 v159, v159
    v_rcp_f32 v160, v160
    v_rcp_f32 v161, v161
    v_rcp_f32 v162, v162
    v_rcp_f32 v163, v163
    v_rcp_f32 v164, v164
    v_rcp_f32 v165, v165
    s_nop 0
    v_pk_fma_f32 v[218:219], v[166:167], v[158:159], v[218:219]
    v_pk_fma_f32 v[220:221], v[168:169], v[160:161], v[220:221]
    v_pk_fma_f32 v[222:223], v[170:171], v[162:163], v[222:223]
    v_pk_fma_f32 v[224:225], v[172:173], v[164:165], v[224:225]
    v_max_f32 v218, 0, v218
    v_max_f32 v219, 0, v219
    v_max_f32 v220, 0, v220
    v_max_f32 v221, 0, v221
    v_max_f32 v222, 0, v222
    v_max_f32 v223, 0, v223
    v_max_f32 v224, 0, v224
    v_max_f32 v225, 0, v225
    v_pk_add_f32 v[226:227], v[226:227], v[218:219]
    v_pk_add_f32 v[228:229], v[228:229], v[220:221]
    v_pk_add_f32 v[230:231], v[230:231], v[222:223]
    v_pk_add_f32 v[232:233], v[232:233], v[224:225]
    v_cvt_pk_bf16_f32 v226, v226, v227
    v_cvt_pk_bf16_f32 v227, v228, v229
    v_cvt_pk_bf16_f32 v228, v230, v231
    v_cvt_pk_bf16_f32 v229, v232, v233
    buffer_store_dwordx4 v[226:229], v237, s[36:39], 0 offen nt
K_END:
    s_endpgm
K_NOWORK:
    v_lshrrev_b32 v237, 3, v0
    v_min_u32 v234, 48, v237
    v_lshlrev_b32 v238, 2, v237
    v_lshlrev_b32 v239, 2, v234
    v_and_b32 v236, 7, v0
    v_lshlrev_b32 v235, 5, v236
    v_cmp_gt_u32_e64 s[20:21], 52, v237
    s_movk_i32 s22, 272
    v_mad_u32_u24 v6, v234, s22, v235
    v_add_u32 v6, 136048, v6
    v_mul_u32_u24 v7, 144, v234
    v_lshl_add_u32 v7, v236, 4, v7
    v_add_u32 v7, 149376, v7
    ds_read_b32 v238, v238 offset:1792
    ds_read_b32 v239, v239 offset:0
    ds_read_b128 v[218:221], v6
    ds_read_b128 v[222:225], v6 offset:16
    ds_read_b128 v[230:233], v7
    v_lshlrev_b32 v237, 8, v237
    v_add_u32 v237, s13, v237
    v_lshlrev_b32 v237, 7, v237
    v_lshl_add_u32 v237, v236, 4, v237
    s_waitcnt lgkmcnt(0)
    v_cmp_ne_u32_e64 s[22:23], 0, v239
    v_and_b32 v236, -4, v238
    v_lshl_add_u32 v234, v238, 9, v235
    v_add_u32 v234, 79712, v234
    v_and_b32 v238, 3, v238
    v_lshl_add_u32 v235, v238, 9, v235
    v_add_u32 v235, 106336, v235
    s_and_b64 s[20:21], s[20:21], s[22:23]
    v_lshlrev_b32 v226, 16, v230
    v_and_b32 v227, 0xffff0000, v230
    v_lshlrev_b32 v228, 16, v231
    v_and_b32 v229, 0xffff0000, v231
    v_lshlrev_b32 v230, 16, v232
    v_and_b32 v231, 0xffff0000, v232
    v_lshlrev_b32 v232, 16, v233
    v_and_b32 v233, 0xffff0000, v233
    s_branch K_LOOP_DONE
K_TAG_RETRY:
    s_waitcnt lgkmcnt(0)
    s_memrealtime s[52:53]
    s_sleep 4
    global_load_dword v64, v217, s[84:85] sc1
    s_waitcnt vmcnt(0) lgkmcnt(0)
    s_sub_u32 s52, s52, s50
    s_cmp_lt_u32 s52, 0x400000
    s_cbranch_scc1 K_TAGW
    s_branch K_TAGOK
K_POLL_RETRY:
    s_memrealtime s[52:53]
    s_sleep 2
    s_waitcnt lgkmcnt(0)
    s_sub_u32 s52, s52, s50
    s_cmp_lt_u32 s52, 0x400000
    s_cbranch_scc1 K_POLL
    v_cndmask_b32 v174, v174, v217, vcc
    v_cndmask_b32 v175, v175, v217, vcc
    v_cndmask_b32 v176, v176, v217, vcc
    v_cndmask_b32 v177, v177, v217, vcc
    v_cndmask_b32 v178, v178, v217, vcc
    v_cndmask_b32 v179, v179, v217, vcc
    v_cndmask_b32 v180, v180, v217, vcc
    v_cndmask_b32 v181, v181, v217, vcc
    s_branch K_POLLOK
K_LONG_ENTRY:
    s_mov_b32 s14, 32
K_LONG:
    v_add_u32 v6, s14, v2
    s_mul_i32 s15, s14, 12
    s_mov_b64 exec, -1
    v_cmp_gt_u32_sdwa vcc, v174, v6 src0_sel:WORD_1 src1_sel:DWORD
    s_and_saveexec_b64 s[42:43], vcc
    s_cbranch_execz K_LONG_S0
    buffer_load_dwordx3 v[68:70], v182, s[32:35], s15 offen sc1
    s_waitcnt vmcnt(0)
    v_and_b32 v4, 0xfc, v70
    ds_add_rtn_u32 v71, v4, v216 offset:0
    s_waitcnt lgkmcnt(0)
    v_min_u32 v71, 512, v71
    v_mad_u32_u24 v4, v4, s59, v71
    v_lshrrev_b32 v70, 8, v70
    v_add_u32 v71, v4, v4
    ds_write_b32 v4, v70 offset:53824
    ds_write_b64 v71, v[68:69] offset:2048
K_LONG_S0:
    s_mov_b64 exec, -1
    v_cmp_gt_u32_sdwa vcc, v175, v6 src0_sel:WORD_1 src1_sel:DWORD
    s_and_saveexec_b64 s[42:43], vcc
    s_cbranch_execz K_LONG_S1
    buffer_load_dwordx3 v[68:70], v183, s[32:35], s15 offen sc1
    s_waitcnt vmcnt(0)
    v_and_b32 v4, 0xfc, v70
    ds_add_rtn_u32 v71, v4, v216 offset:0
    s_waitcnt lgkmcnt(0)
    v_min_u32 v71, 512, v71
    v_mad_u32_u24 v4, v4, s59, v71
    v_lshrrev_b32 v70, 8, v70
    v_add_u32 v71, v4, v4
    ds_write_b32 v4, v70 offset:53824
    ds_write_b64 v71, v[68:69] offset:2048
K_LONG_S1:
    s_mov_b64 exec, -1
    v_cmp_gt_u32_sdwa vcc, v176, v6 src0_sel:WORD_1 src1_sel:DWORD
    s_and_saveexec_b64 s[42:43], vcc
    s_cbranch_execz K_LONG_S2
    buffer_load_dwordx3 v[68:70], v184, s[32:35], s15 offen sc1
    s_waitcnt vmcnt(0)
    v_and_b32 v4, 0xfc, v70
    ds_add_rtn_u32 v71, v4, v216 offset:0
    s_waitcnt lgkmcnt(0)
    v_min_u32 v71, 512, v71
    v_mad_u32_u24 v4, v4, s59, v71
    v_lshrrev_b32 v70, 8, v70
    v_add_u32 v71, v4, v4
    ds_write_b32 v4, v70 offset:53824
    ds_write_b64 v71, v[68:69] offset:2048
K_LONG_S2:
    s_mov_b64 exec, -1
    v_cmp_gt_u32_sdwa vcc, v177, v6 src0_sel:WORD_1 src1_sel:DWORD
    s_and_saveexec_b64 s[42:43], vcc
    s_cbranch_execz K_LONG_S3
    buffer_load_dwordx3 v[68:70], v185, s[32:35], s15 offen sc1
    s_waitcnt vmcnt(0)
    v_and_b32 v4, 0xfc, v70
    ds_add_rtn_u32 v71, v4, v216 offset:0
    s_waitcnt lgkmcnt(0)
    v_min_u32 v71, 512, v71
    v_mad_u32_u24 v4, v4, s59, v71
    v_lshrrev_b32 v70, 8, v70
    v_add_u32 v71, v4, v4
    ds_write_b32 v4, v70 offset:53824
    ds_write_b64 v71, v[68:69] offset:2048
K_LONG_S3:
    s_mov_b64 exec, -1
    v_cmp_gt_u32_sdwa vcc, v178, v6 src0_sel:WORD_1 src1_sel:DWORD
    s_and_saveexec_b64 s[42:43], vcc
    s_cbranch_execz K_LONG_S4
    buffer_load_dwordx3 v[68:70], v186, s[32:35], s15 offen sc1
    s_waitcnt vmcnt(0)
    v_and_b32 v4, 0xfc, v70
    ds_add_rtn_u32 v71, v4, v216 offset:0
    s_waitcnt lgkmcnt(0)
    v_min_u32 v71, 512, v71
    v_mad_u32_u24 v4, v4, s59, v71
    v_lshrrev_b32 v70, 8, v70
    v_add_u32 v71, v4, v4
    ds_write_b32 v4, v70 offset:53824
    ds_write_b64 v71, v[68:69] offset:2048
K_LONG_S4:
    s_mov_b64 exec, -1
    v_cmp_gt_u32_sdwa vcc, v179, v6 src0_sel:WORD_1 src1_sel:DWORD
    s_and_saveexec_b64 s[42:43], vcc
    s_cbranch_execz K_LONG_S5
    buffer_load_dwordx3 v[68:70], v187, s[32:35], s15 offen sc1
    s_waitcnt vmcnt(0)
    v_and_b32 v4, 0xfc, v70
    ds_add_rtn_u32 v71, v4, v216 offset:0
    s_waitcnt lgkmcnt(0)
    v_min_u32 v71, 512, v71
    v_mad_u32_u24 v4, v4, s59, v71
    v_lshrrev_b32 v70, 8, v70
    v_add_u32 v71, v4, v4
    ds_write_b32 v4, v70 offset:53824
    ds_write_b64 v71, v[68:69] offset:2048
K_LONG_S5:
    s_mov_b64 exec, -1
    v_cmp_gt_u32_sdwa vcc, v180, v6 src0_sel:WORD_1 src1_sel:DWORD
    s_and_saveexec_b64 s[42:43], vcc
    s_cbranch_execz K_LONG_S6
    buffer_load_dwordx3 v[68:70], v188, s[32:35], s15 offen sc1
    s_waitcnt vmcnt(0)
    v_and_b32 v4, 0xfc, v70
    ds_add_rtn_u32 v71, v4, v216 offset:0
    s_waitcnt lgkmcnt(0)
    v_min_u32 v71, 512, v71
    v_mad_u32_u24 v4, v4, s59, v71
    v_lshrrev_b32 v70, 8, v70
    v_add_u32 v71, v4, v4
    ds_write_b32 v4, v70 offset:53824
    ds_write_b64 v71, v[68:69] offset:2048
K_LONG_S6:
    s_mov_b64 exec, -1
    v_cmp_gt_u32_sdwa vcc, v181, v6 src0_sel:WORD_1 src1_sel:DWORD
    s_and_saveexec_b64 s[42:43], vcc
    s_cbranch_execz K_LONG_S7
    buffer_load_dwordx3 v[68:70], v189, s[32:35], s15 offen sc1
    s_waitcnt vmcnt(0)
    v_and_b32 v4, 0xfc, v70
    ds_add_rtn_u32 v71, v4, v216 offset:0
    s_waitcnt lgkmcnt(0)
    v_min_u32 v71, 512, v71
    v_mad_u32_u24 v4, v4, s59, v71
    v_lshrrev_b32 v70, 8, v70
    v_add_u32 v71, v4, v4
    ds_write_b32 v4, v70 offset:53824
    ds_write_b64 v71, v[68:69] offset:2048
K_LONG_S7:
    s_mov_b64 exec, -1
    s_add_u32 s14, s14, 16
    v_cmp_lt_u32 vcc, s14, v214
    s_cbranch_vccnz K_LONG
    s_branch K_PLACED
K_SLOW_ENTRY:
    ds_max_u32 v217, v214 offset:324
    s_waitcnt lgkmcnt(0)
    s_barrier
    ds_read_b32 v5, v217 offset:324
    s_mov_b32 s5, 1
    s_mov_b32 s6, 0
    s_mov_b32 s7, 0
    s_waitcnt lgkmcnt(0)
    v_readfirstlane_b32 s8, v5
    s_branch K_SLOW_BATCH
K_SLOW_NEXT:
    s_add_u32 s6, s6, 1
    s_cmp_lt_u32 s6, 64
    s_cbranch_scc1 K_SLOW_BATCH
    s_mov_b32 s6, 0
    s_add_u32 s7, s7, 16
    s_cmp_ge_u32 s7, s8
    s_cbranch_scc1 K_FINAL
K_SLOW_BATCH:
    s_waitcnt vmcnt(0) lgkmcnt(0)
    s_barrier
    v_mov_b32 v68, 0
    v_mov_b32 v69, 0
    v_mov_b32 v70, 0
    v_mov_b32 v71, 0
    v_mov_b32 v72, 12500
    v_mov_b32 v73, 12500
    v_mov_b32 v74, 12500
    v_mov_b32 v75, 12500
    v_lshlrev_b32 v76, 4, v0
    v_add_u32 v77, 53824, v76
    ds_write_b128 v76, v[68:71] offset:0
    ds_write_b128 v76, v[68:71] offset:8192
    ds_write_b128 v76, v[68:71] offset:16384
    ds_write_b128 v76, v[68:71] offset:24576
    ds_write_b128 v76, v[68:71] offset:32768
    ds_write_b128 v76, v[68:71] offset:40960
    ds_write_b128 v77, v[72:75] offset:0
    ds_write_b128 v77, v[72:75] offset:8192
    ds_write_b128 v77, v[72:75] offset:16384
    v_cmp_gt_u32 vcc, 292, v0
    s_mov_b64 exec, vcc
    ds_write_b128 v76, v[68:71] offset:49152
    v_cmp_gt_u32 vcc, 82, v0
    s_mov_b64 exec, vcc
    ds_write_b128 v77, v[72:75] offset:24576
    s_mov_b64 exec, -1
    s_waitcnt lgkmcnt(0)
    s_barrier
    s_cmp_lg_u32 s3, 0
    s_cbranch_scc1 K_SLOW_S
    s_lshl_b32 s14, s6, 2
    v_add_u32 v7, s14, v3
    s_lshl_b32 s15, s13, 3
    v_mul_u32_u24 v4, 2176, v7
    v_add_u32 v4, s15, v4
    buffer_load_dword v5, v4, s[32:35], 0 offen sc1
    s_mov_b32 s15, 37760
    v_mul_lo_u32 v7, v7, s15
    v_add_u32 v6, s7, v2
    v_mad_u32_u24 v7, v6, 12, v7
    v_add_u32 v7, 561152, v7
    s_waitcnt vmcnt(0)
    v_and_b32 v5, 0x0fff0fff, v5
    v_mad_u32_u16 v4, v5, 12, v7
    v_cmp_gt_u32_sdwa vcc, v5, v6 src0_sel:WORD_1 src1_sel:DWORD
    s_and_saveexec_b64 s[40:41], vcc
    s_cbranch_execz K_SLOW_S
    buffer_load_dwordx3 v[68:70], v4, s[32:35], 0 offen sc1
    s_waitcnt vmcnt(0)
    v_and_b32 v4, 0xfc, v70
    ds_add_rtn_u32 v71, v4, v216 offset:0
    s_waitcnt lgkmcnt(0)
    v_min_u32 v71, 512, v71
    v_mad_u32_u24 v4, v4, s59, v71
    v_lshrrev_b32 v70, 8, v70
    v_add_u32 v71, v4, v4
    ds_write_b32 v4, v70 offset:53824
    ds_write_b64 v71, v[68:69] offset:2048
K_SLOW_S:
    s_mov_b64 exec, -1
    s_waitcnt lgkmcnt(0)
    s_barrier
    s_branch K_RANK
.section .rodata,"a"
.p2align 6
.amdhsa_kernel standalone__edge_featured_mpnn_gatedgcn__graph_kernel
  .amdhsa_next_free_vgpr 242
  .amdhsa_next_free_sgpr 98
  .amdhsa_accum_offset 244
  .amdhsa_group_segment_fixed_size 0
  .amdhsa_kernarg_size 96
  .amdhsa_user_sgpr_count 2
  .amdhsa_user_sgpr_kernarg_segment_ptr 1
  .amdhsa_system_sgpr_workgroup_id_x 1
.end_amdhsa_kernel
```
